```python
import torch

def _softmax(x, axis=-1):
    return torch.softmax(x, dim=axis)

def _gelu(x):
    return torch.nn.functional.gelu(x, approximate='tanh')

def _silu(x):
    return torch.nn.functional.silu(x)

def _sigmoid(x):
    return torch.sigmoid(x)

def _layernorm(x, axis=-1, eps=1e-05):
    m = x.mean(dim=axis, keepdim=True)
    v = x.var(dim=axis, keepdim=True, unbiased=False)
    return (x - m) / torch.sqrt(v + eps)

def _scatter_add(tgt, idx, src, axis=0):
    return tgt.clone().index_add_(axis, idx, src)

def _segment_sum(src, seg, n):
    out = torch.zeros((n,) + src.shape[1:], dtype=src.dtype)
    return out.index_add_(0, seg, src)

def _pad(x, pw):
    flat = tuple((v for pair in reversed(pw) for v in pair))
    return torch.nn.functional.pad(x, flat)
kernel_name = 'standalone__conformer_family_branchformer__speech'

def setup_inputs():

    _w = lambda a: (lambda t: t.to(torch.bfloat16) if t.is_floating_point() else t)(torch.as_tensor(a))
    B, T, D, K = (2, 4000, 144, 31)
    s = float(D) ** (-0.5)
    return {'x': _w((lambda *s: torch.randn(*s, dtype=torch.bfloat16) * 0.05)(B, T, D)), 'w_q': _w((lambda *s: torch.randn(*s, dtype=torch.bfloat16) * 1.6)(D, D) * s), 'w_k': _w((lambda *s: torch.randn(*s, dtype=torch.bfloat16) * 1.6)(D, D) * s), 'w_v': _w((lambda *s: torch.randn(*s, dtype=torch.bfloat16) * 0.8)(D, D) * s), 'w_ao': _w((lambda *s: torch.randn(*s, dtype=torch.bfloat16) * 0.8)(D, D) * s), 'w_up': _w((lambda *s: torch.randn(*s, dtype=torch.bfloat16) * 1.6)(D, 2 * D) * s), 'dw': _w((lambda *s: torch.randn(*s, dtype=torch.bfloat16) * 1.6)(K, D) * (1.0 / K)), 'w_dn': _w((lambda *s: torch.randn(*s, dtype=torch.bfloat16) * 0.8)(D, D) * s), 'w_merge': _w((lambda *s: torch.randn(*s, dtype=torch.bfloat16) * 0.8)(2 * D, D) * s)}

def reference(x, w_q, w_k, w_v, w_ao, w_up, dw, w_dn, w_merge):
    B, T, D = x.shape
    K = dw.shape[0]
    xa = _layernorm(x, axis=-1)
    q = torch.einsum('btd,de->bte', xa, w_q)
    k = torch.einsum('btd,de->bte', xa, w_k)
    v = torch.einsum('btd,de->bte', xa, w_v)
    logits = torch.einsum('btd,bsd->bts', q, k) * float(D) ** (-0.5)
    attn = _softmax(logits, axis=-1)
    ya = torch.einsum('bts,bsd->btd', attn, v)
    ya = torch.einsum('btd,de->bte', ya, w_ao)
    xc = _layernorm(x, axis=-1)
    h = _gelu(torch.einsum('btd,de->bte', xc, w_up))
    u = h[..., :D].clone()
    g = _layernorm(h[..., D:], axis=-1)
    pad = K // 2
    gp = _pad(g, ((0, 0), (pad, pad), (0, 0)))
    conv = torch.zeros_like(g)
    for i in range(K):
        conv = conv + gp[:, i:i + T, :] * dw[i][None, None, :]
    yc = torch.einsum('btd,de->bte', u * conv, w_dn)
    merged = torch.concatenate([ya, yc], axis=-1)
    out = torch.einsum('btf,fd->btd', merged, w_merge)
    return x + out
```

```asm
; @launch grid=(256,1,1) block=(512,1,1) lds=163840
.amdgcn_target "amdgcn-amd-amdhsa--gfx950"
.text
.globl standalone__conformer_family_branchformer__speech_kernel
.p2align 8
.type standalone__conformer_family_branchformer__speech_kernel,@function
standalone__conformer_family_branchformer__speech_kernel:
s_cmp_ge_u32 s2, 256
s_cbranch_scc1 K2_END
s_load_dwordx16 s[4:19], s[0:1], 0
s_load_dwordx8 s[20:27], s[0:1], 64
v_lshrrev_b32 v2, 6, v0
v_and_b32 v1, 63, v0
v_readfirstlane_b32 s76, v2
v_lshlrev_b32 v10, 4, v1
v_mov_b32 v2, 0
s_getpc_b64 s[60:61]
P1_PC:
s_sub_u32 s60, s60, P1_PC-standalone__conformer_family_branchformer__speech_kernel
s_subb_u32 s61, s61, 0
s_lshr_b32 s56, s2, 3
s_and_b32 s56, s56, 3
s_lshl_b32 s56, s56, 13
v_lshlrev_b32 v96, 4, v0
v_add_u32 v96, s56, v96
v_min_u32 v96, K2_RARE_A-standalone__conformer_family_branchformer__speech_kernel, v96
global_load_dwordx4 v[100:103], v96, s[60:61]
s_and_b32 s56, s2, 7
s_lshr_b32 s57, s2, 3
s_and_b32 s47, s57, 1
s_lshr_b32 s57, s57, 1
s_add_u32 s57, s57, 15
s_and_b32 s63, s57, 15
s_lshr_b32 s3, s56, 2
s_and_b32 s56, s56, 3
s_lshl_b32 s62, s56, 4
s_add_u32 s62, s62, s63
s_mul_i32 s42, s3, 125
s_lshl_b32 s56, s62, 1
s_add_u32 s42, s42, s56
s_lshr_b32 s43, s76, 2
s_add_u32 s79, s56, s43
s_mul_i32 s45, s43, 9216
s_mov_b32 s39, 99
s_cmp_eq_u32 s76, 0
s_cselect_b32 s39, 0, s39
s_cmp_eq_u32 s76, 5
s_cselect_b32 s39, 1, s39
s_lshl_b32 s56, s47, 1
s_add_u32 s56, s56, s3
s_lshl_b32 s56, s56, 6
s_add_u32 s56, s56, s62
s_lshl_b32 s56, s56, 7
s_add_u32 s78, s56, 20987904
v_add_u32 v8, s45, v10
s_waitcnt lgkmcnt(0)
s_add_u32 s60, s26, 21020672
s_addc_u32 s61, s27, 0
s_load_dword s77, s[60:61], 0
s_mov_b32 s68, s4
s_and_b32 s69, s5, 0xffff
s_mov_b32 s70, 2304000
s_mov_b32 s71, 0x00020000
s_mov_b32 s64, s26
s_and_b32 s65, s27, 0xffff
s_mov_b32 s66, 22020096
s_mov_b32 s67, 0x00020000
s_cmp_ge_u32 s62, 63
s_cbranch_scc1 P1_NOX
s_mul_i32 s57, s76, 2304
s_mul_i32 s56, s42, 9216
s_add_u32 m0, s57, 18432
s_add_u32 s56, s56, s57
buffer_load_dwordx4 v10, s[68:71], s56 offen lds
buffer_load_dwordx4 v10, s[68:71], s56 offen offset:1024 lds
s_mov_b64 exec, 0xffff
buffer_load_dwordx4 v10, s[68:71], s56 offen offset:2048 lds
s_mov_b64 exec, -1
P1_NOX:
s_barrier
s_mov_b32 s72, s22
s_and_b32 s73, s23, 0xffff
s_mov_b32 s74, 2304000
s_mov_b32 s75, 0x00020000
s_cmp_ge_u32 s62, 63
s_cbranch_scc1 P1_WL
s_mov_b32 s80, s14
s_and_b32 s81, s15, 0xffff
s_mov_b32 s82, 82944
s_mov_b32 s83, 0x00020000
s_cmp_eq_u32 s47, 1
s_cbranch_scc1 P1_GL
s_mov_b32 s84, s6
s_and_b32 s85, s7, 0xffff
s_mov_b32 s86, 41472
s_mov_b32 s87, 0x00020000
s_mov_b32 s88, s8
s_and_b32 s89, s9, 0xffff
s_mov_b32 s90, 41472
s_mov_b32 s91, 0x00020000
s_add_u32 s56, s76, s63
s_and_b32 s56, s56, 7
s_mul_i32 s57, s56, 5120
s_add_u32 m0, s57, 36864
s_nop 0
buffer_load_dwordx4 v10, s[84:87], s57 offen offset:0 lds
buffer_load_dwordx4 v10, s[84:87], s57 offen offset:1024 lds
buffer_load_dwordx4 v10, s[84:87], s57 offen offset:2048 lds
buffer_load_dwordx4 v10, s[84:87], s57 offen offset:3072 lds
s_add_u32 m0, m0, 4096
s_add_u32 s57, s57, 4096
buffer_load_dwordx4 v10, s[84:87], s57 offen lds
s_lshl_b32 s57, s76, 6
s_add_u32 m0, s57, 77824
s_add_u32 s57, s57, 40960
s_mov_b64 exec, 0xf
buffer_load_dwordx4 v10, s[84:87], s57 offen lds
s_mov_b64 exec, -1
s_branch P1_COMMON
P1_WL:
s_lshl_b32 s46, s3, 1
s_add_u32 s46, s46, s47
s_mov_b32 s88, s20
s_and_b32 s89, s21, 0xffff
s_mov_b32 s90, 82944
s_mov_b32 s91, 0x00020000
s_mov_b32 s92, s16
s_and_b32 s93, s17, 0xffff
s_mov_b32 s94, 8928
s_mov_b32 s95, 0x00020000
v_and_b32 v52, 0x13, v1
v_bfe_u32 v53, v1, 3, 1
v_bfe_u32 v54, v1, 2, 1
v_lshl_add_u32 v52, v53, 2, v52
v_lshl_add_u32 v52, v54, 3, v52
v_mul_u32_u24 v52, 288, v52
v_lshrrev_b32 v53, 5, v1
v_lshl_add_u32 v7, v53, 4, v52
s_cmp_eq_u32 s46, 3
s_cbranch_scc1 P1_WL3
s_lshl_b32 s59, s46, 1
s_add_u32 s59, s59, s43
s_mul_i32 s58, s59, 9216
s_mov_b32 s80, s10
s_and_b32 s81, s11, 0xffff
s_mov_b32 s82, 41472
s_mov_b32 s83, 0x00020000
s_mov_b32 s84, s12
s_and_b32 s85, s13, 0xffff
s_mov_b32 s86, 41472
s_mov_b32 s87, 0x00020000
s_cmp_ge_u32 s59, 5
s_cbranch_scc1 P1_W_NOV
buffer_load_dwordx4 v[60:63], v7, s[80:83], s58 offen offset:0
buffer_load_dwordx4 v[64:67], v7, s[80:83], s58 offen offset:32
buffer_load_dwordx4 v[68:71], v7, s[80:83], s58 offen offset:64
buffer_load_dwordx4 v[72:75], v7, s[80:83], s58 offen offset:96
buffer_load_dwordx4 v[76:79], v7, s[80:83], s58 offen offset:128
buffer_load_dwordx4 v[80:83], v7, s[80:83], s58 offen offset:160
buffer_load_dwordx4 v[84:87], v7, s[80:83], s58 offen offset:192
buffer_load_dwordx4 v[88:91], v7, s[80:83], s58 offen offset:224
buffer_load_dwordx4 v[92:95], v7, s[80:83], s58 offen offset:256
P1_W_NOV:
s_add_u32 s56, s76, s63
s_and_b32 s56, s56, 7
s_mul_i32 s57, s56, 5120
s_add_u32 m0, s57, 36864
s_nop 0
buffer_load_dwordx4 v10, s[84:87], s57 offen offset:0 lds
buffer_load_dwordx4 v10, s[84:87], s57 offen offset:1024 lds
buffer_load_dwordx4 v10, s[84:87], s57 offen offset:2048 lds
buffer_load_dwordx4 v10, s[84:87], s57 offen offset:3072 lds
s_add_u32 m0, m0, 4096
s_add_u32 s57, s57, 4096
buffer_load_dwordx4 v10, s[84:87], s57 offen lds
s_lshl_b32 s57, s76, 6
s_add_u32 m0, s57, 77824
s_add_u32 s57, s57, 40960
s_mov_b64 exec, 0xf
buffer_load_dwordx4 v10, s[84:87], s57 offen lds
s_mov_b64 exec, -1
s_add_u32 s56, s76, s63
s_and_b32 s56, s56, 7
s_mul_i32 s57, s56, 5120
s_add_u32 m0, s57, 78848
s_nop 0
buffer_load_dwordx4 v10, s[88:91], s57 offen offset:0 lds
buffer_load_dwordx4 v10, s[88:91], s57 offen offset:1024 lds
buffer_load_dwordx4 v10, s[88:91], s57 offen offset:2048 lds
buffer_load_dwordx4 v10, s[88:91], s57 offen offset:3072 lds
s_add_u32 m0, m0, 4096
s_add_u32 s57, s57, 4096
buffer_load_dwordx4 v10, s[88:91], s57 offen lds
s_lshl_b32 s57, s76, 6
s_add_u32 m0, s57, 119808
s_add_u32 s57, s57, 40960
s_mov_b64 exec, 0xf
buffer_load_dwordx4 v10, s[88:91], s57 offen lds
s_mov_b64 exec, -1
s_branch P1_COMMON
P1_WL3:
s_mov_b32 s80, s18
s_and_b32 s81, s19, 0xffff
s_mov_b32 s82, 41472
s_mov_b32 s83, 0x00020000
s_add_u32 s56, s76, s63
s_and_b32 s56, s56, 7
s_mul_i32 s57, s56, 5120
s_add_u32 m0, s57, 36864
s_nop 0
buffer_load_dwordx4 v10, s[80:83], s57 offen offset:0 lds
buffer_load_dwordx4 v10, s[80:83], s57 offen offset:1024 lds
buffer_load_dwordx4 v10, s[80:83], s57 offen offset:2048 lds
buffer_load_dwordx4 v10, s[80:83], s57 offen offset:3072 lds
s_add_u32 m0, m0, 4096
s_add_u32 s57, s57, 4096
buffer_load_dwordx4 v10, s[80:83], s57 offen lds
s_lshl_b32 s57, s76, 6
s_add_u32 m0, s57, 77824
s_add_u32 s57, s57, 40960
s_mov_b64 exec, 0xf
buffer_load_dwordx4 v10, s[80:83], s57 offen lds
s_mov_b64 exec, -1
s_add_u32 s56, s76, s63
s_and_b32 s56, s56, 7
s_mul_i32 s57, s56, 5120
s_add_u32 m0, s57, 78848
s_add_u32 s57, s57, 41472
buffer_load_dwordx4 v10, s[88:91], s57 offen offset:0 lds
buffer_load_dwordx4 v10, s[88:91], s57 offen offset:1024 lds
buffer_load_dwordx4 v10, s[88:91], s57 offen offset:2048 lds
buffer_load_dwordx4 v10, s[88:91], s57 offen offset:3072 lds
s_add_u32 m0, m0, 4096
s_add_u32 s57, s57, 4096
buffer_load_dwordx4 v10, s[88:91], s57 offen lds
s_lshl_b32 s57, s76, 6
s_add_u32 m0, s57, 119808
s_add_u32 s57, s57, 82432
s_mov_b64 exec, 0xf
buffer_load_dwordx4 v10, s[88:91], s57 offen lds
s_mov_b64 exec, -1
s_branch P1_COMMON
P1_GL:
v_add_u32 v44, 0, v1
v_mul_u32_u24 v45, 3277, v44
v_lshrrev_b32 v45, 16, v45
v_lshlrev_b32 v44, 4, v44
v_lshl_add_u32 v44, v45, 8, v44
v_add_u32 v12, 256, v44
v_add_u32 v44, 64, v1
v_mul_u32_u24 v45, 3277, v44
v_lshrrev_b32 v45, 16, v45
v_lshlrev_b32 v44, 4, v44
v_lshl_add_u32 v44, v45, 8, v44
v_add_u32 v13, -768, v44
v_add_u32 v44, 128, v1
v_mul_u32_u24 v45, 3277, v44
v_lshrrev_b32 v45, 16, v45
v_lshlrev_b32 v44, 4, v44
v_lshl_add_u32 v44, v45, 8, v44
v_add_u32 v14, -1792, v44
v_add_u32 v44, 192, v1
v_mul_u32_u24 v45, 3277, v44
v_lshrrev_b32 v45, 16, v45
v_lshlrev_b32 v44, 4, v44
v_lshl_add_u32 v44, v45, 8, v44
v_add_u32 v15, -2816, v44
v_add_u32 v44, 256, v1
v_mul_u32_u24 v45, 3277, v44
v_lshrrev_b32 v45, 16, v45
v_lshlrev_b32 v44, 4, v44
v_lshl_add_u32 v44, v45, 8, v44
v_add_u32 v16, 256, v44
s_add_u32 s56, s76, s63
s_and_b32 s56, s56, 7
s_mul_i32 s57, s56, 5120
s_add_u32 m0, s57, 36864
s_mul_i32 s56, s56, 9216
buffer_load_dwordx4 v12, s[80:83], s56 offen offset:0 lds
buffer_load_dwordx4 v13, s[80:83], s56 offen offset:1024 lds
buffer_load_dwordx4 v14, s[80:83], s56 offen offset:2048 lds
buffer_load_dwordx4 v15, s[80:83], s56 offen offset:3072 lds
s_add_u32 m0, m0, 4096
s_nop 0
buffer_load_dwordx4 v16, s[80:83], s56 offen offset:0 lds
s_mov_b32 s56, 73728
s_cmp_eq_u32 s76, 0
s_cbranch_scc0 P1_G8g0
s_mov_b32 m0, 77824
s_nop 0
buffer_load_dwordx4 v12, s[80:83], s56 offen offset:0 lds
P1_G8g0:
s_cmp_eq_u32 s76, 1
s_cbranch_scc0 P1_G8g1
s_mov_b32 m0, 77824
s_nop 0
buffer_load_dwordx4 v13, s[80:83], s56 offen offset:1024 lds
P1_G8g1:
s_cmp_eq_u32 s76, 2
s_cbranch_scc0 P1_G8g2
s_mov_b32 m0, 77824
s_nop 0
buffer_load_dwordx4 v14, s[80:83], s56 offen offset:2048 lds
P1_G8g2:
s_cmp_eq_u32 s76, 3
s_cbranch_scc0 P1_G8g3
s_mov_b32 m0, 77824
s_nop 0
buffer_load_dwordx4 v15, s[80:83], s56 offen offset:3072 lds
P1_G8g3:
s_cmp_eq_u32 s76, 4
s_cbranch_scc0 P1_G8g4
s_mov_b32 m0, 81920
s_nop 0
buffer_load_dwordx4 v16, s[80:83], s56 offen offset:0 lds
P1_G8g4:
P1_COMMON:
s_and_b32 s26, s2, 7
s_lshr_b32 s27, s2, 3
s_and_b32 s16, s27, 3
s_lshr_b32 s27, s27, 2
s_lshl_b32 s28, s26, 3
s_add_u32 s31, s27, s28
s_lshr_b32 s49, s31, 5
s_and_b32 s51, s31, 31
s_and_b32 s12, s76, 3
s_lshr_b32 s13, s76, 2
s_lshl_b32 s27, s51, 2
s_mul_i32 s26, s49, 125
s_add_u32 s25, s26, s27
s_add_u32 s48, s27, s16
s_add_u32 s27, s27, s12
s_cmp_lt_u32 s27, 125
s_cselect_b32 s17, 1, 0
s_add_u32 s15, s25, s12
s_lshl_b32 s27, s13, 1
s_add_u32 s25, s25, s27
s_mul_i32 s40, s25, 9216
s_add_u32 s40, s40, 2392064
s_mul_i32 s30, s13, 73728
s_mul_i32 s25, s12, 4608
s_add_u32 s24, s30, s25
v_add_u32 v28, s25, v10
s_lshl_b32 s27, s16, 1
s_add_u32 s27, s27, s13
s_cmp_lt_u32 s27, 5
s_cselect_b32 s14, 16, 15
s_max_u32 s28, s27, 5
s_sub_u32 s28, s28, 5
s_lshl_b32 s27, s27, 4
s_sub_u32 s27, s27, s28
s_lshr_b32 s28, s27, 1
v_min_u32 v34, 16, v1
v_add_u32 v34, s28, v34
v_min_u32 v34, 62, v34
s_lshl_b32 s28, s49, 13
s_add_u32 s28, s28, 21495808
v_lshlrev_b32 v34, 7, v34
v_add_u32 v34, s28, v34
v_bfe_u32 v35, v1, 3, 1
s_lshl_b32 s28, s51, 1
v_add_u32 v35, s28, v35
v_min_u32 v35, 62, v35
v_and_b32 v36, 7, v1
v_lshl_add_u32 v35, v35, 3, v36
s_lshl_b32 s28, s49, 16
s_add_u32 s28, s28, 21037056
v_lshlrev_b32 v35, 7, v35
v_cmp_lt_u32 vcc, 31, v1
v_add_u32 v35, s28, v35
s_nop 0
v_cndmask_b32 v31, v34, v35, vcc
s_add_u32 s27, s27, s26
s_mul_i32 s41, s27, 9216
s_add_u32 s41, s41, 16384
s_cmp_lt_u32 s48, 125
s_cselect_b32 s35, 1, 0
s_min_u32 s48, s48, 124
s_add_u32 s34, s26, s48
v_min_u32 v34, 7, v1
v_add_u32 v35, s48, v34
v_max_u32 v35, 2, v35
v_subrev_u32 v35, 2, v35
v_lshrrev_b32 v35, 1, v35
v_min_u32 v35, 62, v35
s_lshl_b32 s28, s49, 6
s_add_u32 s25, s28, 128
v_add_u32 v35, s25, v35
s_lshr_b32 s25, s48, 1
s_add_u32 s25, s25, s28
v_mov_b32 v37, s25
v_and_b32 v36, 3, v34
v_lshlrev_b32 v36, 6, v36
v_add_u32 v36, 63, v36
v_cmp_eq_u32 vcc, 0, v34
s_mul_i32 s50, s49, 127
s_add_u32 s50, s50, s48
v_cndmask_b32 v35, v35, v37, vcc
v_cmp_lt_u32 vcc, 3, v34
s_mul_i32 s50, s50, 9216
s_add_u32 s50, s50, 16650752
v_cndmask_b32 v35, v35, v36, vcc
v_lshlrev_b32 v35, 7, v35
v_add_u32 v32, 20987904, v35
s_mov_b32 s51, 19156992
s_cmp_eq_u32 s13, 0
s_cselect_b32 s32, 19120128, s50
s_cselect_b32 s33, 19138560, s51
s_sub_u32 s48, s12, s16
s_add_u32 s48, s48, 3
s_and_b32 s48, s48, 3
s_lshl_b32 s49, s13, 1
s_add_u32 s49, s49, s48
s_mul_i32 s7, s49, 9216
s_add_u32 s7, s7, 19070976
s_mul_i32 s6, s12, 9216
s_add_u32 s6, s6, 110592
s_sub_u32 s6, s6, s30
s_cmp_eq_u32 s48, 3
s_cselect_b32 s6, 0, s6
s_lshl_b32 s48, s48, 1
s_add_u32 s48, s48, s13
s_cmp_eq_u32 s48, 1
s_cselect_b32 s6, 0, s6
s_lshl_b32 s55, s31, 12
s_lshl_b32 s49, s12, 10
s_add_u32 s55, s55, s49
s_lshl_b32 s48, s48, 7
s_add_u32 s55, s55, s48
s_add_u32 s55, s55, 21233664
s_cmp_eq_u32 s12, s16
s_cselect_b32 s55, 0, s55
s_cmp_eq_u32 s17, 0
s_cselect_b32 s55, 0, s55
v_bfe_u32 v34, v1, 2, 1
v_bfe_u32 v35, v1, 3, 1
v_bfe_u32 v36, v1, 4, 1
v_and_b32 v37, 3, v1
v_lshrrev_b32 v38, 5, v1
v_xor_b32 v39, v38, v34
v_lshl_add_u32 v40, v34, 1, v35
v_mad_u32_u24 v39, v37, 36, v39
v_mad_u32_u24 v39, v36, 18, v39
v_mul_u32_u24 v40, 144, v40
v_add_lshl_u32 v39, v39, v40, 4
v_add_u32 v24, s30, v39
v_bfe_u32 v34, v1, 2, 2
v_bfe_u32 v35, v1, 1, 1
v_xor_b32 v35, v35, v38
v_mad_u32_u24 v35, v34, 36, v35
v_mad_u32_u24 v35, v36, 18, v35
v_mul_u32_u24 v39, 288, v38
v_add_lshl_u32 v35, v35, v39, 4
v_and_b32 v39, 1, v1
v_lshl_add_u32 v35, v39, 3, v35
v_add_u32 v25, s30, v35
s_lshr_b32 s25, s12, 1
s_mul_i32 s25, s25, 73728
s_and_b32 s26, s12, 1
s_mul_i32 s26, s26, 9216
s_add_u32 s25, s25, s26
v_add_u32 v29, s25, v10
s_mov_b32 s21, 55296
s_mov_b32 s22, 55296
v_add_u32 v26, s22, v24
v_add_u32 v27, s21, v25
s_mov_b32 s22, 0
s_mul_i32 s26, s12, 2304
v_add_u32 v30, s26, v10
s_add_u32 s26, s26, s30
s_mov_b32 s18, s40
s_mov_b32 s20, 36864
v_accvgpr_write_b32 a112, v24
v_accvgpr_write_b32 a113, v25
v_accvgpr_write_b32 a114, v26
v_accvgpr_write_b32 a115, v27
v_accvgpr_write_b32 a116, v28
v_accvgpr_write_b32 a117, v29
v_accvgpr_write_b32 a118, v30
v_accvgpr_write_b32 a119, v31
v_accvgpr_write_b32 a120, v32
s_cmp_eq_u32 s76, 7
s_cbranch_scc0 K2_NOWARM
buffer_load_dword v42, v31, s[64:67], 0 offen sc1
s_lshl_b32 s25, s31, 12
s_lshl_b32 s27, s16, 10
s_add_u32 s25, s25, s27
s_add_u32 s25, s25, 21233664
v_min_u32 v41, 5, v1
v_lshlrev_b32 v41, 7, v41
buffer_load_dword v43, v41, s[64:67], s25 offen sc1
K2_NOWARM:
s_mov_b32 s8, 0
s_waitcnt lgkmcnt(0)
s_add_u32 s77, s77, 1
s_cmp_ge_u32 s62, 63
s_cbranch_scc1 P1_WTYPE
v_lshrrev_b32 v44, 3, v1
v_and_b32 v45, 7, v1
v_mul_u32_u24 v46, 288, v44
v_lshl_add_u32 v46, v45, 2, v46
s_mul_i32 s57, s76, 2304
s_add_u32 s57, s57, 18432
v_add_u32 v5, s57, v46
s_lshl_b32 s57, s76, 3
v_add_u32 v44, s57, v44
v_lshrrev_b32 v47, 2, v45
v_bfe_u32 v49, v44, 2, 1
v_bfe_u32 v50, v44, 3, 1
v_lshl_add_u32 v50, v49, 1, v50
v_xor_b32 v49, v47, v49
v_and_b32 v51, 3, v44
v_mad_u32_u24 v49, v51, 36, v49
v_bfe_u32 v51, v44, 4, 1
v_mad_u32_u24 v49, v51, 18, v49
v_mul_u32_u24 v50, 144, v50
v_add_lshl_u32 v48, v49, v50, 4
v_and_b32 v45, 3, v45
v_lshl_add_u32 v44, v45, 2, v48
v_add_u32 v6, s45, v44
s_waitcnt vmcnt(5)
ds_read2_b32 v[12:13], v5 offset0:0 offset1:8
ds_read2_b32 v[14:15], v5 offset0:16 offset1:24
ds_read2_b32 v[16:17], v5 offset0:32 offset1:40
ds_read2_b32 v[18:19], v5 offset0:48 offset1:56
ds_read_b32 v20, v5 offset:256
s_waitcnt lgkmcnt(4)
v_lshlrev_b32 v24, 16, v12
v_and_b32 v25, 0xffff0000, v12
v_lshlrev_b32 v26, 16, v13
v_and_b32 v27, 0xffff0000, v13
s_waitcnt lgkmcnt(3)
v_lshlrev_b32 v28, 16, v14
v_and_b32 v29, 0xffff0000, v14
v_lshlrev_b32 v30, 16, v15
v_and_b32 v31, 0xffff0000, v15
s_waitcnt lgkmcnt(2)
v_lshlrev_b32 v32, 16, v16
v_and_b32 v33, 0xffff0000, v16
v_lshlrev_b32 v34, 16, v17
v_and_b32 v35, 0xffff0000, v17
s_waitcnt lgkmcnt(1)
v_lshlrev_b32 v36, 16, v18
v_and_b32 v37, 0xffff0000, v18
v_lshlrev_b32 v38, 16, v19
v_and_b32 v39, 0xffff0000, v19
s_waitcnt lgkmcnt(0)
v_lshlrev_b32 v40, 16, v20
v_and_b32 v41, 0xffff0000, v20
v_pk_add_f32 v[44:45], v[24:25], v[26:27]
v_pk_add_f32 v[44:45], v[44:45], v[28:29]
v_pk_add_f32 v[44:45], v[44:45], v[30:31]
v_pk_add_f32 v[44:45], v[44:45], v[32:33]
v_pk_add_f32 v[44:45], v[44:45], v[34:35]
v_pk_add_f32 v[44:45], v[44:45], v[36:37]
v_pk_add_f32 v[44:45], v[44:45], v[38:39]
v_pk_add_f32 v[44:45], v[44:45], v[40:41]
v_add_f32 v44, v44, v45
s_nop 1
v_add_f32_dpp v45, v44, v44 quad_perm:[1,0,3,2] row_mask:0xf bank_mask:0xf
s_nop 1
v_add_f32_dpp v44, v45, v45 quad_perm:[2,3,0,1] row_mask:0xf bank_mask:0xf
s_nop 1
v_add_f32_dpp v45, v44, v44 row_half_mirror row_mask:0xf bank_mask:0xf
v_mul_f32 v44, 0x3be38e39, v45
v_cvt_pk_bf16_f32 v46, v44, v44
v_and_b32 v46, 0xffff0000, v46
v_sub_f32 v47, v44, v46
v_pk_add_f32 v[24:25], v[24:25], v[46:47] op_sel_hi:[1,0] neg_lo:[0,1] neg_hi:[0,1]
v_pk_add_f32 v[26:27], v[26:27], v[46:47] op_sel_hi:[1,0] neg_lo:[0,1] neg_hi:[0,1]
v_pk_add_f32 v[28:29], v[28:29], v[46:47] op_sel_hi:[1,0] neg_lo:[0,1] neg_hi:[0,1]
v_pk_add_f32 v[30:31], v[30:31], v[46:47] op_sel_hi:[1,0] neg_lo:[0,1] neg_hi:[0,1]
v_pk_add_f32 v[32:33], v[32:33], v[46:47] op_sel_hi:[1,0] neg_lo:[0,1] neg_hi:[0,1]
v_pk_add_f32 v[34:35], v[34:35], v[46:47] op_sel_hi:[1,0] neg_lo:[0,1] neg_hi:[0,1]
v_pk_add_f32 v[36:37], v[36:37], v[46:47] op_sel_hi:[1,0] neg_lo:[0,1] neg_hi:[0,1]
v_pk_add_f32 v[38:39], v[38:39], v[46:47] op_sel_hi:[1,0] neg_lo:[0,1] neg_hi:[0,1]
v_pk_add_f32 v[40:41], v[40:41], v[46:47] op_sel_hi:[1,0] neg_lo:[0,1] neg_hi:[0,1]
v_pk_mul_f32 v[48:49], v[24:25], v[24:25]
v_pk_fma_f32 v[48:49], v[26:27], v[26:27], v[48:49]
v_pk_fma_f32 v[48:49], v[28:29], v[28:29], v[48:49]
v_pk_fma_f32 v[48:49], v[30:31], v[30:31], v[48:49]
v_pk_fma_f32 v[48:49], v[32:33], v[32:33], v[48:49]
v_pk_fma_f32 v[48:49], v[34:35], v[34:35], v[48:49]
v_pk_fma_f32 v[48:49], v[36:37], v[36:37], v[48:49]
v_pk_fma_f32 v[48:49], v[38:39], v[38:39], v[48:49]
v_pk_fma_f32 v[48:49], v[40:41], v[40:41], v[48:49]
v_add_f32 v48, v48, v49
v_cvt_pk_bf16_f32 v12, v24, v25
v_cvt_pk_bf16_f32 v13, v26, v27
v_cvt_pk_bf16_f32 v14, v28, v29
v_cvt_pk_bf16_f32 v15, v30, v31
v_cvt_pk_bf16_f32 v16, v32, v33
v_cvt_pk_bf16_f32 v17, v34, v35
v_cvt_pk_bf16_f32 v18, v36, v37
v_cvt_pk_bf16_f32 v19, v38, v39
v_cvt_pk_bf16_f32 v20, v40, v41
v_add_f32_dpp v49, v48, v48 quad_perm:[1,0,3,2] row_mask:0xf bank_mask:0xf
s_nop 1
v_add_f32_dpp v48, v49, v49 quad_perm:[2,3,0,1] row_mask:0xf bank_mask:0xf
s_nop 1
v_add_f32_dpp v49, v48, v48 row_half_mirror row_mask:0xf bank_mask:0xf
v_mul_f32 v48, 0x3be38e39, v49
v_fma_f32 v48, -v47, v47, v48
v_max_f32 v48, 0, v48
v_cvt_pk_bf16_f32 v48, v48, v48
v_and_b32 v48, 0xffff0000, v48
v_add_f32 v48, 0x3727c5ac, v48
v_cvt_pk_bf16_f32 v48, v48, v48
v_and_b32 v48, 0xffff0000, v48
v_sqrt_f32 v48, v48
v_lshlrev_b32 v24, 16, v12
v_and_b32 v25, 0xffff0000, v12
v_cvt_pk_bf16_f32 v48, v48, v48
v_and_b32 v48, 0xffff0000, v48
v_lshlrev_b32 v26, 16, v13
v_and_b32 v27, 0xffff0000, v13
v_rcp_f32 v48, v48
v_lshlrev_b32 v28, 16, v14
v_and_b32 v29, 0xffff0000, v14
v_lshlrev_b32 v30, 16, v15
v_and_b32 v31, 0xffff0000, v15
v_lshlrev_b32 v32, 16, v16
v_and_b32 v33, 0xffff0000, v16
v_lshlrev_b32 v34, 16, v17
v_and_b32 v35, 0xffff0000, v17
v_lshlrev_b32 v36, 16, v18
v_and_b32 v37, 0xffff0000, v18
v_lshlrev_b32 v38, 16, v19
v_and_b32 v39, 0xffff0000, v19
v_lshlrev_b32 v40, 16, v20
v_and_b32 v41, 0xffff0000, v20
v_pk_mul_f32 v[24:25], v[24:25], v[48:49] op_sel_hi:[1,0]
v_pk_mul_f32 v[26:27], v[26:27], v[48:49] op_sel_hi:[1,0]
v_pk_mul_f32 v[28:29], v[28:29], v[48:49] op_sel_hi:[1,0]
v_pk_mul_f32 v[30:31], v[30:31], v[48:49] op_sel_hi:[1,0]
v_pk_mul_f32 v[32:33], v[32:33], v[48:49] op_sel_hi:[1,0]
v_pk_mul_f32 v[34:35], v[34:35], v[48:49] op_sel_hi:[1,0]
v_pk_mul_f32 v[36:37], v[36:37], v[48:49] op_sel_hi:[1,0]
v_pk_mul_f32 v[38:39], v[38:39], v[48:49] op_sel_hi:[1,0]
v_pk_mul_f32 v[40:41], v[40:41], v[48:49] op_sel_hi:[1,0]
v_cvt_pk_bf16_f32 v12, v24, v25
ds_write_b32 v6, v12 offset:0
v_cvt_pk_bf16_f32 v13, v26, v27
ds_write_b32 v6, v13 offset:32
v_cvt_pk_bf16_f32 v14, v28, v29
ds_write_b32 v6, v14 offset:64
v_cvt_pk_bf16_f32 v15, v30, v31
ds_write_b32 v6, v15 offset:96
v_cvt_pk_bf16_f32 v16, v32, v33
ds_write_b32 v6, v16 offset:128
v_cvt_pk_bf16_f32 v17, v34, v35
ds_write_b32 v6, v17 offset:160
v_cvt_pk_bf16_f32 v18, v36, v37
ds_write_b32 v6, v18 offset:192
v_cvt_pk_bf16_f32 v19, v38, v39
ds_write_b32 v6, v19 offset:224
v_cvt_pk_bf16_f32 v20, v40, v41
ds_write_b32 v6, v20 offset:256
s_cmp_eq_u32 s47, 1
s_cbranch_scc1 P1_G
s_add_u32 s56, s76, s63
s_and_b32 s56, s56, 7
s_mul_i32 s57, s56, 5120
s_add_u32 m0, s57, 78848
s_nop 0
buffer_load_dwordx4 v10, s[88:91], s57 offen offset:0 lds
buffer_load_dwordx4 v10, s[88:91], s57 offen offset:1024 lds
buffer_load_dwordx4 v10, s[88:91], s57 offen offset:2048 lds
buffer_load_dwordx4 v10, s[88:91], s57 offen offset:3072 lds
s_add_u32 m0, m0, 4096
s_add_u32 s57, s57, 4096
buffer_load_dwordx4 v10, s[88:91], s57 offen lds
s_lshl_b32 s57, s76, 6
s_add_u32 m0, s57, 119808
s_add_u32 s57, s57, 40960
s_mov_b64 exec, 0xf
buffer_load_dwordx4 v10, s[88:91], s57 offen lds
s_mov_b64 exec, -1
v_lshrrev_b32 v44, 5, v1
v_bfe_u32 v45, v1, 2, 2
v_lshl_add_u32 v44, v44, 3, v45
v_mul_u32_u24 v44, 288, v44
v_bfe_u32 v45, v1, 4, 1
v_lshl_add_u32 v44, v45, 5, v44
v_and_b32 v45, 1, v1
v_lshl_add_u32 v44, v45, 4, v44
v_bfe_u32 v45, v1, 1, 1
v_lshl_add_u32 v11, v45, 3, v44
v_and_b32 v52, 0x13, v1
v_bfe_u32 v53, v1, 3, 1
v_bfe_u32 v54, v1, 2, 1
v_lshl_add_u32 v52, v53, 2, v52
v_lshl_add_u32 v52, v54, 3, v52
v_mul_u32_u24 v52, 288, v52
v_lshrrev_b32 v53, 5, v1
v_lshl_add_u32 v7, v53, 4, v52
v_bfe_u32 v44, v1, 2, 1
v_bfe_u32 v45, v1, 3, 1
v_lshl_add_u32 v45, v44, 1, v45
v_xor_b32 v44, v53, v44
v_and_b32 v46, 3, v1
v_mad_u32_u24 v44, v46, 36, v44
v_bfe_u32 v46, v1, 4, 1
v_mad_u32_u24 v44, v46, 18, v44
v_mul_u32_u24 v45, 144, v45
v_add_lshl_u32 v9, v44, v45, 4
v_add_u32 v9, s45, v9
s_and_b32 s44, s76, 3
v_lshrrev_b32 v44, 5, v1
v_bfe_u32 v45, v1, 2, 2
v_lshl_add_u32 v44, v44, 3, v45
v_mul_u32_u24 v44, 256, v44
v_bfe_u32 v45, v1, 4, 1
v_lshl_add_u32 v44, v45, 5, v44
v_and_b32 v45, 1, v1
v_lshl_add_u32 v44, v45, 4, v44
v_bfe_u32 v45, v1, 1, 1
v_lshl_add_u32 v5, v45, 3, v44
v_bfe_u32 v45, v1, 2, 2
v_xor_b32 v45, s44, v45
v_lshl_add_u32 v5, v45, 6, v5
v_add_u32 v5, 120832, v5
v_mov_b32 v22, 0xbdd2d3e8
v_mov_b32 v23, 0xc0135761
v_lshrrev_b32 v44, 4, v1
v_lshlrev_b32 v45, 2, v44
v_and_b32 v46, 15, v1
v_xor_b32 v46, v46, v45
v_mul_u32_u24 v44, 576, v44
s_waitcnt vmcnt(6) lgkmcnt(0)
v_lshl_add_u32 v12, v46, 4, v44
v_add_u32 v13, 1280, v12
v_add_u32 v14, 2560, v12
v_add_u32 v15, 3840, v12
s_barrier
s_and_b32 s44, s76, 3
s_lshl_b32 s56, s44, 6
s_add_u32 s56, s56, 36864
v_add_u32 v3, s56, v11
s_cmp_eq_u32 s39, 99
s_cbranch_scc1 P1_Q1S
v_add_u32 v4, 37120, v11
ds_read_b128 v[60:63], v9 offset:0
ds_read_b64_tr_b16 a[0:1], v3 offset:0
ds_read_b64_tr_b16 a[2:3], v3 offset:1152
ds_read_b64_tr_b16 a[32:33], v4 offset:0
ds_read_b64_tr_b16 a[34:35], v4 offset:1152
ds_read_b128 v[64:67], v9 offset:32
ds_read_b64_tr_b16 a[4:5], v3 offset:4608
ds_read_b64_tr_b16 a[6:7], v3 offset:5760
ds_read_b64_tr_b16 a[36:37], v4 offset:4608
ds_read_b64_tr_b16 a[38:39], v4 offset:5760
ds_read_b128 v[68:71], v9 offset:64
ds_read_b64_tr_b16 a[8:9], v3 offset:9216
ds_read_b64_tr_b16 a[10:11], v3 offset:10368
ds_read_b64_tr_b16 a[40:41], v4 offset:9216
ds_read_b64_tr_b16 a[42:43], v4 offset:10368
s_waitcnt lgkmcnt(10)
v_mfma_f32_32x32x16_bf16 v[24:39], a[0:3], v[60:63], 0
v_mfma_f32_32x32x16_bf16 v[96:111], a[32:35], v[60:63], 0
ds_read_b128 v[72:75], v9 offset:96
ds_read_b64_tr_b16 a[12:13], v3 offset:13824
ds_read_b64_tr_b16 a[14:15], v3 offset:14976
ds_read_b64_tr_b16 a[44:45], v4 offset:13824
ds_read_b64_tr_b16 a[46:47], v4 offset:14976
s_waitcnt lgkmcnt(10)
v_mfma_f32_32x32x16_bf16 v[24:39], a[4:7], v[64:67], v[24:39]
v_mfma_f32_32x32x16_bf16 v[96:111], a[36:39], v[64:67], v[96:111]
ds_read_b128 v[76:79], v9 offset:128
ds_read_b64_tr_b16 a[16:17], v3 offset:18432
ds_read_b64_tr_b16 a[18:19], v3 offset:19584
ds_read_b64_tr_b16 a[48:49], v4 offset:18432
ds_read_b64_tr_b16 a[50:51], v4 offset:19584
s_waitcnt lgkmcnt(10)
v_mfma_f32_32x32x16_bf16 v[24:39], a[8:11], v[68:71], v[24:39]
v_mfma_f32_32x32x16_bf16 v[96:111], a[40:43], v[68:71], v[96:111]
ds_read_b128 v[80:83], v9 offset:160
ds_read_b64_tr_b16 a[20:21], v3 offset:23040
ds_read_b64_tr_b16 a[22:23], v3 offset:24192
ds_read_b64_tr_b16 a[52:53], v4 offset:23040
ds_read_b64_tr_b16 a[54:55], v4 offset:24192
s_waitcnt lgkmcnt(10)
v_mfma_f32_32x32x16_bf16 v[24:39], a[12:15], v[72:75], v[24:39]
v_mfma_f32_32x32x16_bf16 v[96:111], a[44:47], v[72:75], v[96:111]
ds_read_b128 v[84:87], v9 offset:192
ds_read_b64_tr_b16 a[24:25], v3 offset:27648
ds_read_b64_tr_b16 a[26:27], v3 offset:28800
ds_read_b64_tr_b16 a[56:57], v4 offset:27648
ds_read_b64_tr_b16 a[58:59], v4 offset:28800
s_waitcnt lgkmcnt(10)
v_mfma_f32_32x32x16_bf16 v[24:39], a[16:19], v[76:79], v[24:39]
v_mfma_f32_32x32x16_bf16 v[96:111], a[48:51], v[76:79], v[96:111]
ds_read_b128 v[88:91], v9 offset:224
ds_read_b64_tr_b16 a[28:29], v3 offset:32256
ds_read_b64_tr_b16 a[30:31], v3 offset:33408
ds_read_b64_tr_b16 a[60:61], v4 offset:32256
ds_read_b64_tr_b16 a[62:63], v4 offset:33408
s_waitcnt lgkmcnt(10)
v_mfma_f32_32x32x16_bf16 v[24:39], a[20:23], v[80:83], v[24:39]
v_mfma_f32_32x32x16_bf16 v[96:111], a[52:55], v[80:83], v[96:111]
ds_read_b128 v[92:95], v9 offset:256
ds_read_b64_tr_b16 a[0:1], v3 offset:36864
ds_read_b64_tr_b16 a[2:3], v3 offset:38016
ds_read_b64_tr_b16 a[32:33], v4 offset:36864
ds_read_b64_tr_b16 a[34:35], v4 offset:38016
s_waitcnt lgkmcnt(10)
v_mfma_f32_32x32x16_bf16 v[24:39], a[24:27], v[84:87], v[24:39]
v_mfma_f32_32x32x16_bf16 v[96:111], a[56:59], v[84:87], v[96:111]
s_waitcnt lgkmcnt(5)
v_mfma_f32_32x32x16_bf16 v[24:39], a[28:31], v[88:91], v[24:39]
v_mfma_f32_32x32x16_bf16 v[96:111], a[60:63], v[88:91], v[96:111]
s_waitcnt lgkmcnt(0)
v_mfma_f32_32x32x16_bf16 v[24:39], a[0:3], v[92:95], v[24:39]
v_mfma_f32_32x32x16_bf16 v[96:111], a[32:35], v[92:95], v[96:111]
s_nop 11
v_cvt_pk_bf16_f32 v52, v96, v97
v_cvt_pk_bf16_f32 v53, v98, v99
v_cvt_pk_bf16_f32 v54, v100, v101
v_cvt_pk_bf16_f32 v55, v102, v103
ds_write_b128 v8, v[52:55] offset:26624
s_branch P1_Q1J
P1_Q1S:
ds_read_b128 v[60:63], v9 offset:0
ds_read_b64_tr_b16 a[0:1], v3 offset:0
ds_read_b64_tr_b16 a[2:3], v3 offset:1152
ds_read_b128 v[64:67], v9 offset:32
ds_read_b64_tr_b16 a[4:5], v3 offset:4608
ds_read_b64_tr_b16 a[6:7], v3 offset:5760
ds_read_b128 v[68:71], v9 offset:64
ds_read_b64_tr_b16 a[8:9], v3 offset:9216
ds_read_b64_tr_b16 a[10:11], v3 offset:10368
ds_read_b128 v[72:75], v9 offset:96
ds_read_b64_tr_b16 a[12:13], v3 offset:13824
ds_read_b64_tr_b16 a[14:15], v3 offset:14976
ds_read_b128 v[76:79], v9 offset:128
ds_read_b64_tr_b16 a[16:17], v3 offset:18432
ds_read_b64_tr_b16 a[18:19], v3 offset:19584
s_waitcnt lgkmcnt(12)
v_mfma_f32_32x32x16_bf16 v[24:39], a[0:3], v[60:63], 0
ds_read_b128 v[80:83], v9 offset:160
ds_read_b64_tr_b16 a[20:21], v3 offset:23040
ds_read_b64_tr_b16 a[22:23], v3 offset:24192
s_waitcnt lgkmcnt(12)
v_mfma_f32_32x32x16_bf16 v[24:39], a[4:7], v[64:67], v[24:39]
ds_read_b128 v[84:87], v9 offset:192
ds_read_b64_tr_b16 a[24:25], v3 offset:27648
ds_read_b64_tr_b16 a[26:27], v3 offset:28800
s_waitcnt lgkmcnt(12)
v_mfma_f32_32x32x16_bf16 v[24:39], a[8:11], v[68:71], v[24:39]
ds_read_b128 v[88:91], v9 offset:224
ds_read_b64_tr_b16 a[28:29], v3 offset:32256
ds_read_b64_tr_b16 a[30:31], v3 offset:33408
s_waitcnt lgkmcnt(12)
v_mfma_f32_32x32x16_bf16 v[24:39], a[12:15], v[72:75], v[24:39]
ds_read_b128 v[92:95], v9 offset:256
ds_read_b64_tr_b16 a[0:1], v3 offset:36864
ds_read_b64_tr_b16 a[2:3], v3 offset:38016
s_waitcnt lgkmcnt(12)
v_mfma_f32_32x32x16_bf16 v[24:39], a[16:19], v[76:79], v[24:39]
s_waitcnt lgkmcnt(9)
v_mfma_f32_32x32x16_bf16 v[24:39], a[20:23], v[80:83], v[24:39]
s_waitcnt lgkmcnt(6)
v_mfma_f32_32x32x16_bf16 v[24:39], a[24:27], v[84:87], v[24:39]
s_waitcnt lgkmcnt(3)
v_mfma_f32_32x32x16_bf16 v[24:39], a[28:31], v[88:91], v[24:39]
s_waitcnt lgkmcnt(0)
v_mfma_f32_32x32x16_bf16 v[24:39], a[0:3], v[92:95], v[24:39]
P1_Q1J:
s_nop 11
v_cvt_pk_bf16_f32 v44, v24, v25
v_cvt_pk_bf16_f32 v45, v26, v27
v_cvt_pk_bf16_f32 v46, v28, v29
v_cvt_pk_bf16_f32 v47, v30, v31
v_cvt_pk_bf16_f32 v48, v32, v33
v_cvt_pk_bf16_f32 v49, v34, v35
v_cvt_pk_bf16_f32 v50, v36, v37
v_cvt_pk_bf16_f32 v51, v38, v39
s_lshl_b32 s56, s44, 11
v_add_u32 v6, s56, v8
ds_write_b128 v6, v[44:47] offset:18432
s_cmp_eq_u32 s44, 4
s_cbranch_scc1 P1_Q1W
ds_write_b128 v6, v[48:51] offset:19456
P1_Q1W:
s_waitcnt lgkmcnt(0)
s_waitcnt vmcnt(0)
s_add_u32 s56, s76, s63
s_and_b32 s56, s56, 7
s_mul_i32 s57, s56, 4096
s_add_u32 m0, s57, 120832
s_mul_i32 s56, s56, 9216
buffer_load_dwordx4 v12, s[80:83], s56 offen offset:0 lds
buffer_load_dwordx4 v13, s[80:83], s56 offen offset:1024 lds
buffer_load_dwordx4 v14, s[80:83], s56 offen offset:2048 lds
buffer_load_dwordx4 v15, s[80:83], s56 offen offset:3072 lds
s_mov_b32 s56, 73728
s_cmp_eq_u32 s76, 0
s_cbranch_scc0 P1_G8u0
s_mov_b32 m0, 153600
s_nop 0
buffer_load_dwordx4 v12, s[80:83], s56 offen offset:0 lds
P1_G8u0:
s_cmp_eq_u32 s76, 1
s_cbranch_scc0 P1_G8u1
s_mov_b32 m0, 153600
s_nop 0
buffer_load_dwordx4 v13, s[80:83], s56 offen offset:1024 lds
P1_G8u1:
s_cmp_eq_u32 s76, 2
s_cbranch_scc0 P1_G8u2
s_mov_b32 m0, 153600
s_nop 0
buffer_load_dwordx4 v14, s[80:83], s56 offen offset:2048 lds
P1_G8u2:
s_cmp_eq_u32 s76, 3
s_cbranch_scc0 P1_G8u3
s_mov_b32 m0, 153600
s_nop 0
buffer_load_dwordx4 v15, s[80:83], s56 offen offset:3072 lds
P1_G8u3:
s_barrier
s_add_u32 s58, s42, s43
s_mul_i32 s58, s58, 9216
s_mov_b32 s46, 0x3df6384f
s_mul_i32 s56, s44, 9216
s_add_u32 s56, s56, 78848
v_add_u32 v3, s56, v7
s_lshl_b32 s56, s44, 11
s_add_u32 s59, s58, s56
s_add_u32 s59, s59, 2392064
s_cmp_eq_u32 s39, 99
s_cbranch_scc1 P1_Q2A
v_add_u32 v4, 115712, v7
ds_read_b128 v[60:63], v8 offset:18432
ds_read_b128 a[0:3], v3 offset:0
ds_read_b128 a[32:35], v4 offset:0
ds_read_b128 v[64:67], v8 offset:19456
ds_read_b128 a[4:7], v3 offset:32
ds_read_b128 a[36:39], v4 offset:32
ds_read_b128 v[68:71], v8 offset:20480
ds_read_b128 a[8:11], v3 offset:64
ds_read_b128 a[40:43], v4 offset:64
ds_read_b128 v[72:75], v8 offset:21504
ds_read_b128 a[12:15], v3 offset:96
ds_read_b128 a[44:47], v4 offset:96
ds_read_b128 v[76:79], v8 offset:22528
ds_read_b128 a[16:19], v3 offset:128
ds_read_b128 a[48:51], v4 offset:128
s_waitcnt lgkmcnt(12)
v_mfma_f32_32x32x16_bf16 v[24:39], a[0:3], v[60:63], 0
v_mfma_f32_32x32x16_bf16 v[96:111], a[32:35], v[60:63], 0
ds_read_b128 v[80:83], v8 offset:23552
ds_read_b128 a[20:23], v3 offset:160
ds_read_b128 a[52:55], v4 offset:160
s_waitcnt lgkmcnt(12)
v_mfma_f32_32x32x16_bf16 v[24:39], a[4:7], v[64:67], v[24:39]
v_mfma_f32_32x32x16_bf16 v[96:111], a[36:39], v[64:67], v[96:111]
ds_read_b128 v[84:87], v8 offset:24576
ds_read_b128 a[24:27], v3 offset:192
ds_read_b128 a[56:59], v4 offset:192
s_waitcnt lgkmcnt(12)
v_mfma_f32_32x32x16_bf16 v[24:39], a[8:11], v[68:71], v[24:39]
v_mfma_f32_32x32x16_bf16 v[96:111], a[40:43], v[68:71], v[96:111]
ds_read_b128 v[88:91], v8 offset:25600
ds_read_b128 a[28:31], v3 offset:224
ds_read_b128 a[60:63], v4 offset:224
s_waitcnt lgkmcnt(12)
v_mfma_f32_32x32x16_bf16 v[24:39], a[12:15], v[72:75], v[24:39]
v_mfma_f32_32x32x16_bf16 v[96:111], a[44:47], v[72:75], v[96:111]
ds_read_b128 v[92:95], v8 offset:26624
ds_read_b128 a[0:3], v3 offset:256
ds_read_b128 a[32:35], v4 offset:256
s_waitcnt lgkmcnt(12)
v_mfma_f32_32x32x16_bf16 v[24:39], a[16:19], v[76:79], v[24:39]
v_mfma_f32_32x32x16_bf16 v[96:111], a[48:51], v[76:79], v[96:111]
s_waitcnt lgkmcnt(9)
v_mfma_f32_32x32x16_bf16 v[24:39], a[20:23], v[80:83], v[24:39]
v_mfma_f32_32x32x16_bf16 v[96:111], a[52:55], v[80:83], v[96:111]
s_waitcnt lgkmcnt(6)
v_mfma_f32_32x32x16_bf16 v[24:39], a[24:27], v[84:87], v[24:39]
v_mfma_f32_32x32x16_bf16 v[96:111], a[56:59], v[84:87], v[96:111]
s_waitcnt lgkmcnt(3)
v_mfma_f32_32x32x16_bf16 v[24:39], a[28:31], v[88:91], v[24:39]
v_mfma_f32_32x32x16_bf16 v[96:111], a[60:63], v[88:91], v[96:111]
s_waitcnt lgkmcnt(0)
v_mfma_f32_32x32x16_bf16 v[24:39], a[0:3], v[92:95], v[24:39]
v_mfma_f32_32x32x16_bf16 v[96:111], a[32:35], v[92:95], v[96:111]
s_add_u32 s57, s58, 2400256
s_nop 10
v_mul_f32 v96, s46, v96
v_mul_f32 v97, s46, v97
v_mul_f32 v98, s46, v98
v_mul_f32 v99, s46, v99
v_mul_f32 v100, s46, v100
v_mul_f32 v101, s46, v101
v_mul_f32 v102, s46, v102
v_mul_f32 v103, s46, v103
v_cvt_pk_bf16_f32 v52, v96, v97
v_cvt_pk_bf16_f32 v53, v98, v99
v_cvt_pk_bf16_f32 v54, v100, v101
v_cvt_pk_bf16_f32 v55, v102, v103
s_cmp_ge_u32 s79, 125
s_cbranch_scc1 P1_Q2B
buffer_store_dwordx4 v[52:55], v10, s[64:67], s57 offen sc1
s_branch P1_Q2B
P1_Q2A:
ds_read_b128 v[60:63], v8 offset:18432
ds_read_b128 a[0:3], v3 offset:0
ds_read_b128 v[64:67], v8 offset:19456
ds_read_b128 a[4:7], v3 offset:32
ds_read_b128 v[68:71], v8 offset:20480
ds_read_b128 a[8:11], v3 offset:64
ds_read_b128 v[72:75], v8 offset:21504
ds_read_b128 a[12:15], v3 offset:96
ds_read_b128 v[76:79], v8 offset:22528
ds_read_b128 a[16:19], v3 offset:128
ds_read_b128 v[80:83], v8 offset:23552
ds_read_b128 a[20:23], v3 offset:160
ds_read_b128 v[84:87], v8 offset:24576
ds_read_b128 a[24:27], v3 offset:192
s_waitcnt lgkmcnt(12)
v_mfma_f32_32x32x16_bf16 v[24:39], a[0:3], v[60:63], 0
ds_read_b128 v[88:91], v8 offset:25600
ds_read_b128 a[28:31], v3 offset:224
s_waitcnt lgkmcnt(12)
v_mfma_f32_32x32x16_bf16 v[24:39], a[4:7], v[64:67], v[24:39]
ds_read_b128 v[92:95], v8 offset:26624
ds_read_b128 a[0:3], v3 offset:256
s_waitcnt lgkmcnt(12)
v_mfma_f32_32x32x16_bf16 v[24:39], a[8:11], v[68:71], v[24:39]
s_waitcnt lgkmcnt(10)
v_mfma_f32_32x32x16_bf16 v[24:39], a[12:15], v[72:75], v[24:39]
s_waitcnt lgkmcnt(8)
v_mfma_f32_32x32x16_bf16 v[24:39], a[16:19], v[76:79], v[24:39]
s_waitcnt lgkmcnt(6)
v_mfma_f32_32x32x16_bf16 v[24:39], a[20:23], v[80:83], v[24:39]
s_waitcnt lgkmcnt(4)
v_mfma_f32_32x32x16_bf16 v[24:39], a[24:27], v[84:87], v[24:39]
s_waitcnt lgkmcnt(2)
v_mfma_f32_32x32x16_bf16 v[24:39], a[28:31], v[88:91], v[24:39]
s_waitcnt lgkmcnt(0)
v_mfma_f32_32x32x16_bf16 v[24:39], a[0:3], v[92:95], v[24:39]
P1_Q2B:
s_nop 11
v_mul_f32 v24, s46, v24
v_mul_f32 v25, s46, v25
v_mul_f32 v26, s46, v26
v_mul_f32 v27, s46, v27
v_mul_f32 v28, s46, v28
v_mul_f32 v29, s46, v29
v_mul_f32 v30, s46, v30
v_mul_f32 v31, s46, v31
v_mul_f32 v32, s46, v32
v_mul_f32 v33, s46, v33
v_mul_f32 v34, s46, v34
v_mul_f32 v35, s46, v35
v_mul_f32 v36, s46, v36
v_mul_f32 v37, s46, v37
v_mul_f32 v38, s46, v38
v_mul_f32 v39, s46, v39
v_cvt_pk_bf16_f32 v44, v24, v25
v_cvt_pk_bf16_f32 v45, v26, v27
v_cvt_pk_bf16_f32 v46, v28, v29
v_cvt_pk_bf16_f32 v47, v30, v31
v_cvt_pk_bf16_f32 v48, v32, v33
v_cvt_pk_bf16_f32 v49, v34, v35
v_cvt_pk_bf16_f32 v50, v36, v37
v_cvt_pk_bf16_f32 v51, v38, v39
s_waitcnt vmcnt(1)
s_cmp_eq_u32 s39, 99
s_cbranch_scc0 P1_Q2C
s_waitcnt vmcnt(0)
P1_Q2C:
s_cmp_ge_u32 s79, 125
s_cbranch_scc0 P1_Q2D
s_waitcnt vmcnt(0)
s_branch P1_Q2S
P1_Q2D:
buffer_store_dwordx4 v[44:47], v10, s[64:67], s59 offen sc1
buffer_store_dwordx4 v[48:51], v10, s[64:67], s59 offen offset:1024 sc1
P1_Q2S:
s_barrier
ds_read_b128 v[60:63], v9 offset:0
ds_read_b64_tr_b16 a[0:1], v5 offset:0
ds_read_b64_tr_b16 a[2:3], v5 offset:1024
ds_read_b128 v[64:67], v9 offset:32
ds_read_b64_tr_b16 a[4:5], v5 offset:4096
ds_read_b64_tr_b16 a[6:7], v5 offset:5120
ds_read_b128 v[68:71], v9 offset:64
ds_read_b64_tr_b16 a[8:9], v5 offset:8192
ds_read_b64_tr_b16 a[10:11], v5 offset:9216
ds_read_b128 v[72:75], v9 offset:96
ds_read_b64_tr_b16 a[12:13], v5 offset:12288
ds_read_b64_tr_b16 a[14:15], v5 offset:13312
ds_read_b128 v[76:79], v9 offset:128
ds_read_b64_tr_b16 a[16:17], v5 offset:16384
ds_read_b64_tr_b16 a[18:19], v5 offset:17408
s_waitcnt lgkmcnt(12)
v_mfma_f32_32x32x16_bf16 v[96:111], a[0:3], v[60:63], 0
ds_read_b128 v[80:83], v9 offset:160
ds_read_b64_tr_b16 a[20:21], v5 offset:20480
ds_read_b64_tr_b16 a[22:23], v5 offset:21504
s_waitcnt lgkmcnt(12)
v_mfma_f32_32x32x16_bf16 v[96:111], a[4:7], v[64:67], v[96:111]
ds_read_b128 v[84:87], v9 offset:192
ds_read_b64_tr_b16 a[24:25], v5 offset:24576
ds_read_b64_tr_b16 a[26:27], v5 offset:25600
s_waitcnt lgkmcnt(12)
v_mfma_f32_32x32x16_bf16 v[96:111], a[8:11], v[68:71], v[96:111]
ds_read_b128 v[88:91], v9 offset:224
ds_read_b64_tr_b16 a[28:29], v5 offset:28672
ds_read_b64_tr_b16 a[30:31], v5 offset:29696
s_waitcnt lgkmcnt(12)
v_mfma_f32_32x32x16_bf16 v[96:111], a[12:15], v[72:75], v[96:111]
ds_read_b128 v[92:95], v9 offset:256
ds_read_b64_tr_b16 a[0:1], v5 offset:32768
ds_read_b64_tr_b16 a[2:3], v5 offset:33792
s_waitcnt lgkmcnt(12)
v_mfma_f32_32x32x16_bf16 v[96:111], a[16:19], v[76:79], v[96:111]
s_waitcnt lgkmcnt(9)
v_mfma_f32_32x32x16_bf16 v[96:111], a[20:23], v[80:83], v[96:111]
s_waitcnt lgkmcnt(6)
v_mfma_f32_32x32x16_bf16 v[96:111], a[24:27], v[84:87], v[96:111]
s_waitcnt lgkmcnt(3)
v_mfma_f32_32x32x16_bf16 v[96:111], a[28:31], v[88:91], v[96:111]
s_waitcnt lgkmcnt(0)
v_mfma_f32_32x32x16_bf16 v[96:111], a[0:3], v[92:95], v[96:111]
s_lshl_b32 s56, s3, 6
s_add_u32 s56, s56, s62
s_lshl_b32 s56, s56, 3
s_add_u32 s56, s56, s76
s_lshl_b32 s56, s56, 7
s_add_u32 s56, s56, 21037056
s_waitcnt vmcnt(0)
v_mov_b32 v59, s77
v_lshrrev_b32 v58, 2, v10
s_mov_b64 exec, 0xffffffff
buffer_store_dword v59, v58, s[64:67], s56 offen sc1
s_mov_b64 exec, -1
v_pk_mul_f32 v[60:61], v[96:97], v[96:97]
v_pk_mul_f32 v[62:63], v[98:99], v[98:99]
v_pk_mul_f32 v[64:65], v[100:101], v[100:101]
v_pk_mul_f32 v[66:67], v[102:103], v[102:103]
v_pk_mul_f32 v[68:69], v[104:105], v[104:105]
v_pk_mul_f32 v[70:71], v[106:107], v[106:107]
v_pk_mul_f32 v[72:73], v[108:109], v[108:109]
v_pk_mul_f32 v[74:75], v[110:111], v[110:111]
v_pk_fma_f32 v[60:61], v[60:61], v[22:23], v[22:23] op_sel:[0,0,1] op_sel_hi:[1,0,1]
v_pk_fma_f32 v[62:63], v[62:63], v[22:23], v[22:23] op_sel:[0,0,1] op_sel_hi:[1,0,1]
v_pk_fma_f32 v[64:65], v[64:65], v[22:23], v[22:23] op_sel:[0,0,1] op_sel_hi:[1,0,1]
v_pk_fma_f32 v[66:67], v[66:67], v[22:23], v[22:23] op_sel:[0,0,1] op_sel_hi:[1,0,1]
v_pk_fma_f32 v[68:69], v[68:69], v[22:23], v[22:23] op_sel:[0,0,1] op_sel_hi:[1,0,1]
v_pk_fma_f32 v[70:71], v[70:71], v[22:23], v[22:23] op_sel:[0,0,1] op_sel_hi:[1,0,1]
v_pk_fma_f32 v[72:73], v[72:73], v[22:23], v[22:23] op_sel:[0,0,1] op_sel_hi:[1,0,1]
v_pk_fma_f32 v[74:75], v[74:75], v[22:23], v[22:23] op_sel:[0,0,1] op_sel_hi:[1,0,1]
v_pk_mul_f32 v[60:61], v[60:61], v[96:97]
v_pk_mul_f32 v[62:63], v[62:63], v[98:99]
v_pk_mul_f32 v[64:65], v[64:65], v[100:101]
v_pk_mul_f32 v[66:67], v[66:67], v[102:103]
v_pk_mul_f32 v[68:69], v[68:69], v[104:105]
v_pk_mul_f32 v[70:71], v[70:71], v[106:107]
v_pk_mul_f32 v[72:73], v[72:73], v[108:109]
v_pk_mul_f32 v[74:75], v[74:75], v[110:111]
v_exp_f32 v60, v60
v_exp_f32 v61, v61
v_exp_f32 v62, v62
v_exp_f32 v63, v63
v_exp_f32 v64, v64
v_exp_f32 v65, v65
v_exp_f32 v66, v66
v_exp_f32 v67, v67
v_exp_f32 v68, v68
v_exp_f32 v69, v69
v_exp_f32 v70, v70
v_exp_f32 v71, v71
v_exp_f32 v72, v72
v_exp_f32 v73, v73
v_exp_f32 v74, v74
v_exp_f32 v75, v75
v_pk_add_f32 v[60:61], v[60:61], 1.0 op_sel_hi:[1,0]
v_pk_add_f32 v[62:63], v[62:63], 1.0 op_sel_hi:[1,0]
v_pk_add_f32 v[64:65], v[64:65], 1.0 op_sel_hi:[1,0]
v_pk_add_f32 v[66:67], v[66:67], 1.0 op_sel_hi:[1,0]
v_pk_add_f32 v[68:69], v[68:69], 1.0 op_sel_hi:[1,0]
v_pk_add_f32 v[70:71], v[70:71], 1.0 op_sel_hi:[1,0]
v_pk_add_f32 v[72:73], v[72:73], 1.0 op_sel_hi:[1,0]
v_pk_add_f32 v[74:75], v[74:75], 1.0 op_sel_hi:[1,0]
v_rcp_f32 v60, v60
v_rcp_f32 v61, v61
v_rcp_f32 v62, v62
v_rcp_f32 v63, v63
v_rcp_f32 v64, v64
v_rcp_f32 v65, v65
v_rcp_f32 v66, v66
v_rcp_f32 v67, v67
v_rcp_f32 v68, v68
v_rcp_f32 v69, v69
v_rcp_f32 v70, v70
v_rcp_f32 v71, v71
v_rcp_f32 v72, v72
v_rcp_f32 v73, v73
v_rcp_f32 v74, v74
v_rcp_f32 v75, v75
v_pk_mul_f32 v[96:97], v[96:97], v[60:61]
v_pk_mul_f32 v[98:99], v[98:99], v[62:63]
v_pk_mul_f32 v[100:101], v[100:101], v[64:65]
v_pk_mul_f32 v[102:103], v[102:103], v[66:67]
v_pk_mul_f32 v[104:105], v[104:105], v[68:69]
v_pk_mul_f32 v[106:107], v[106:107], v[70:71]
v_pk_mul_f32 v[108:109], v[108:109], v[72:73]
v_pk_mul_f32 v[110:111], v[110:111], v[74:75]
v_cvt_pk_bf16_f32 v44, v96, v97
v_cvt_pk_bf16_f32 v45, v98, v99
v_cvt_pk_bf16_f32 v46, v100, v101
v_cvt_pk_bf16_f32 v47, v102, v103
v_cvt_pk_bf16_f32 v48, v104, v105
v_cvt_pk_bf16_f32 v49, v106, v107
v_cvt_pk_bf16_f32 v50, v108, v109
v_cvt_pk_bf16_f32 v51, v110, v111
s_cmp_ge_u32 s79, 125
s_cbranch_scc1 P1_DONE
s_lshl_b32 s56, s44, 11
s_add_u32 s59, s58, s56
s_add_u32 s8, s59, 14286848
s_add_u32 s9, s8, 1024
s_mov_b32 s10, -1
v_mov_b32 v104, v44
v_mov_b32 v105, v45
v_mov_b32 v106, v46
v_mov_b32 v107, v47
v_mov_b32 v108, v48
v_mov_b32 v109, v49
v_mov_b32 v110, v50
v_mov_b32 v111, v51
v_mov_b32 v98, v10
s_branch P1_DONE
P1_G:
v_mov_b32 v56, 163832
ds_write_b32 v56, v2
v_lshrrev_b32 v44, 5, v1
v_bfe_u32 v45, v1, 2, 2
v_lshl_add_u32 v44, v44, 3, v45
v_mul_u32_u24 v44, 320, v44
v_bfe_u32 v45, v1, 4, 1
v_lshl_add_u32 v44, v45, 5, v44
v_and_b32 v45, 1, v1
v_lshl_add_u32 v44, v45, 4, v44
v_bfe_u32 v45, v1, 1, 1
v_lshl_add_u32 v11, v45, 3, v44
v_lshrrev_b32 v52, 5, v1
v_bfe_u32 v44, v1, 2, 1
v_bfe_u32 v45, v1, 3, 1
v_lshl_add_u32 v45, v44, 1, v45
v_xor_b32 v44, v52, v44
v_and_b32 v46, 3, v1
v_mad_u32_u24 v44, v46, 36, v44
v_bfe_u32 v46, v1, 4, 1
v_mad_u32_u24 v44, v46, 18, v44
v_mul_u32_u24 v45, 144, v45
v_add_lshl_u32 v9, v44, v45, 4
v_add_u32 v9, s45, v9
v_mov_b32 v22, 0xbdd2d3e8
v_mov_b32 v23, 0xc0135761
v_and_b32 v44, 31, v1
v_lshlrev_b32 v45, 3, v44
s_mul_i32 s56, s43, 1280
v_add_u32 v21, s56, v45
s_mul_i32 s56, s76, 2560
s_add_u32 s56, s56, 83968
v_mul_u32_u24 v44, 80, v44
v_lshrrev_b32 v45, 5, v1
v_lshl_add_u32 v44, v45, 4, v44
v_add_u32 v5, s56, v44
v_bfe_u32 v46, v1, 4, 1
v_bfe_u32 v47, v1, 2, 2
v_lshl_add_u32 v47, v46, 4, v47
v_mul_u32_u24 v47, 80, v47
v_lshl_add_u32 v47, v45, 5, v47
v_and_b32 v48, 3, v1
v_lshl_add_u32 v47, v48, 3, v47
v_add_u32 v4, s56, v47
v_and_b32 v48, 15, v1
v_lshl_add_u32 v48, v45, 4, v48
v_lshlrev_b32 v48, 4, v48
v_mul_u32_u24 v46, 4608, v46
v_add_u32 v7, v46, v48
s_add_u32 s58, s42, s43
s_mul_i32 s58, s58, 9216
s_mul_i32 s56, s76, 2304
v_add_u32 v6, s56, v10
s_waitcnt vmcnt(0) lgkmcnt(0)
s_barrier
s_cmp_ge_u32 s79, 125
s_cbranch_scc1 P1_G_NOXA
ds_read_b128 v[44:47], v6 offset:0
ds_read_b128 v[48:51], v6 offset:1024
ds_read_b128 v[52:55], v6 offset:2048
s_mul_i32 s59, s42, 9216
s_add_u32 s59, s59, 16384
s_waitcnt lgkmcnt(0)
buffer_store_dwordx4 v[44:47], v6, s[64:67], s59 offen sc1
buffer_store_dwordx4 v[48:51], v6, s[64:67], s59 offen offset:1024 sc1
s_mov_b64 exec, 0xffff
buffer_store_dwordx4 v[52:55], v6, s[64:67], s59 offen offset:2048 sc1
s_mov_b64 exec, -1
P1_G_NOXA:
s_and_b32 s44, s76, 3
P1_G1:
v_mov_b32 v24, v96
v_mov_b32 v25, v97
v_mov_b32 v26, v98
v_mov_b32 v27, v99
v_mov_b32 v28, v100
v_mov_b32 v29, v101
v_mov_b32 v30, v102
v_mov_b32 v31, v103
v_mov_b32 v32, v104
v_mov_b32 v33, v105
v_mov_b32 v34, v106
v_mov_b32 v35, v107
v_mov_b32 v36, v108
v_mov_b32 v37, v109
v_mov_b32 v38, v110
v_mov_b32 v39, v111
s_lshl_b32 s56, s44, 6
s_add_u32 s56, s56, 36864
v_add_u32 v3, s56, v11
ds_read_b128 v[60:63], v9 offset:0
ds_read_b64_tr_b16 a[0:1], v3 offset:0
ds_read_b64_tr_b16 a[2:3], v3 offset:1280
ds_read_b128 v[64:67], v9 offset:32
ds_read_b64_tr_b16 a[4:5], v3 offset:5120
ds_read_b64_tr_b16 a[6:7], v3 offset:6400
ds_read_b128 v[68:71], v9 offset:64
ds_read_b64_tr_b16 a[8:9], v3 offset:10240
ds_read_b64_tr_b16 a[10:11], v3 offset:11520
ds_read_b128 v[72:75], v9 offset:96
ds_read_b64_tr_b16 a[12:13], v3 offset:15360
ds_read_b64_tr_b16 a[14:15], v3 offset:16640
ds_read_b128 v[76:79], v9 offset:128
ds_read_b64_tr_b16 a[16:17], v3 offset:20480
ds_read_b64_tr_b16 a[18:19], v3 offset:21760
s_waitcnt lgkmcnt(12)
v_mfma_f32_32x32x16_bf16 v[96:111], a[0:3], v[60:63], 0
ds_read_b128 v[80:83], v9 offset:160
ds_read_b64_tr_b16 a[20:21], v3 offset:25600
ds_read_b64_tr_b16 a[22:23], v3 offset:26880
s_waitcnt lgkmcnt(12)
v_mfma_f32_32x32x16_bf16 v[96:111], a[4:7], v[64:67], v[96:111]
ds_read_b128 v[84:87], v9 offset:192
ds_read_b64_tr_b16 a[24:25], v3 offset:30720
ds_read_b64_tr_b16 a[26:27], v3 offset:32000
s_waitcnt lgkmcnt(12)
v_mfma_f32_32x32x16_bf16 v[96:111], a[8:11], v[68:71], v[96:111]
ds_read_b128 v[88:91], v9 offset:224
ds_read_b64_tr_b16 a[28:29], v3 offset:35840
ds_read_b64_tr_b16 a[30:31], v3 offset:37120
s_waitcnt lgkmcnt(12)
v_mfma_f32_32x32x16_bf16 v[96:111], a[12:15], v[72:75], v[96:111]
ds_read_b128 v[92:95], v9 offset:256
ds_read_b64_tr_b16 a[0:1], v3 offset:40960
ds_read_b64_tr_b16 a[2:3], v3 offset:42240
s_waitcnt lgkmcnt(12)
v_mfma_f32_32x32x16_bf16 v[96:111], a[16:19], v[76:79], v[96:111]
s_waitcnt lgkmcnt(9)
v_mfma_f32_32x32x16_bf16 v[96:111], a[20:23], v[80:83], v[96:111]
s_waitcnt lgkmcnt(6)
v_mfma_f32_32x32x16_bf16 v[96:111], a[24:27], v[84:87], v[96:111]
s_waitcnt lgkmcnt(3)
v_mfma_f32_32x32x16_bf16 v[96:111], a[28:31], v[88:91], v[96:111]
s_waitcnt lgkmcnt(0)
v_mfma_f32_32x32x16_bf16 v[96:111], a[0:3], v[92:95], v[96:111]
s_nop 11
v_pk_mul_f32 v[60:61], v[96:97], v[96:97]
v_pk_mul_f32 v[62:63], v[98:99], v[98:99]
v_pk_mul_f32 v[64:65], v[100:101], v[100:101]
v_pk_mul_f32 v[66:67], v[102:103], v[102:103]
v_pk_mul_f32 v[68:69], v[104:105], v[104:105]
v_pk_mul_f32 v[70:71], v[106:107], v[106:107]
v_pk_mul_f32 v[72:73], v[108:109], v[108:109]
v_pk_mul_f32 v[74:75], v[110:111], v[110:111]
v_pk_fma_f32 v[60:61], v[60:61], v[22:23], v[22:23] op_sel:[0,0,1] op_sel_hi:[1,0,1]
v_pk_fma_f32 v[62:63], v[62:63], v[22:23], v[22:23] op_sel:[0,0,1] op_sel_hi:[1,0,1]
v_pk_fma_f32 v[64:65], v[64:65], v[22:23], v[22:23] op_sel:[0,0,1] op_sel_hi:[1,0,1]
v_pk_fma_f32 v[66:67], v[66:67], v[22:23], v[22:23] op_sel:[0,0,1] op_sel_hi:[1,0,1]
v_pk_fma_f32 v[68:69], v[68:69], v[22:23], v[22:23] op_sel:[0,0,1] op_sel_hi:[1,0,1]
v_pk_fma_f32 v[70:71], v[70:71], v[22:23], v[22:23] op_sel:[0,0,1] op_sel_hi:[1,0,1]
v_pk_fma_f32 v[72:73], v[72:73], v[22:23], v[22:23] op_sel:[0,0,1] op_sel_hi:[1,0,1]
v_pk_fma_f32 v[74:75], v[74:75], v[22:23], v[22:23] op_sel:[0,0,1] op_sel_hi:[1,0,1]
v_pk_mul_f32 v[60:61], v[60:61], v[96:97]
v_pk_mul_f32 v[62:63], v[62:63], v[98:99]
v_pk_mul_f32 v[64:65], v[64:65], v[100:101]
v_pk_mul_f32 v[66:67], v[66:67], v[102:103]
v_pk_mul_f32 v[68:69], v[68:69], v[104:105]
v_pk_mul_f32 v[70:71], v[70:71], v[106:107]
v_pk_mul_f32 v[72:73], v[72:73], v[108:109]
v_pk_mul_f32 v[74:75], v[74:75], v[110:111]
v_exp_f32 v60, v60
v_exp_f32 v61, v61
v_exp_f32 v62, v62
v_exp_f32 v63, v63
v_exp_f32 v64, v64
v_exp_f32 v65, v65
v_exp_f32 v66, v66
v_exp_f32 v67, v67
v_exp_f32 v68, v68
v_exp_f32 v69, v69
v_exp_f32 v70, v70
v_exp_f32 v71, v71
v_exp_f32 v72, v72
v_exp_f32 v73, v73
v_exp_f32 v74, v74
v_exp_f32 v75, v75
v_pk_add_f32 v[60:61], v[60:61], 1.0 op_sel_hi:[1,0]
v_pk_add_f32 v[62:63], v[62:63], 1.0 op_sel_hi:[1,0]
v_pk_add_f32 v[64:65], v[64:65], 1.0 op_sel_hi:[1,0]
v_pk_add_f32 v[66:67], v[66:67], 1.0 op_sel_hi:[1,0]
v_pk_add_f32 v[68:69], v[68:69], 1.0 op_sel_hi:[1,0]
v_pk_add_f32 v[70:71], v[70:71], 1.0 op_sel_hi:[1,0]
v_pk_add_f32 v[72:73], v[72:73], 1.0 op_sel_hi:[1,0]
v_pk_add_f32 v[74:75], v[74:75], 1.0 op_sel_hi:[1,0]
v_rcp_f32 v60, v60
v_rcp_f32 v61, v61
v_rcp_f32 v62, v62
v_rcp_f32 v63, v63
v_rcp_f32 v64, v64
v_rcp_f32 v65, v65
v_rcp_f32 v66, v66
v_rcp_f32 v67, v67
v_rcp_f32 v68, v68
v_rcp_f32 v69, v69
v_rcp_f32 v70, v70
v_rcp_f32 v71, v71
v_rcp_f32 v72, v72
v_rcp_f32 v73, v73
v_rcp_f32 v74, v74
v_rcp_f32 v75, v75
v_pk_mul_f32 v[96:97], v[96:97], v[60:61]
v_pk_mul_f32 v[98:99], v[98:99], v[62:63]
v_pk_mul_f32 v[100:101], v[100:101], v[64:65]
v_pk_mul_f32 v[102:103], v[102:103], v[66:67]
v_pk_mul_f32 v[104:105], v[104:105], v[68:69]
v_pk_mul_f32 v[106:107], v[106:107], v[70:71]
v_pk_mul_f32 v[108:109], v[108:109], v[72:73]
v_pk_mul_f32 v[110:111], v[110:111], v[74:75]
s_mov_b32 s46, 1.0
s_cmp_eq_u32 s44, 0
s_cbranch_scc0 P1_G_NOU8
v_cvt_pk_bf16_f32 v44, v96, v97
v_cvt_pk_bf16_f32 v45, v98, v99
v_cvt_pk_bf16_f32 v46, v100, v101
v_cvt_pk_bf16_f32 v47, v102, v103
v_mov_b32 v96, v104
v_mov_b32 v97, v105
v_mov_b32 v98, v106
v_mov_b32 v99, v107
v_mov_b32 v100, v108
v_mov_b32 v101, v109
v_mov_b32 v102, v110
v_mov_b32 v103, v111
s_mov_b32 s46, 0.5
s_cmp_ge_u32 s79, 125
s_cbranch_scc1 P1_G_NOU8
s_add_u32 s59, s58, 14295040
buffer_store_dwordx4 v[44:47], v10, s[64:67], s59 offen sc1
P1_G_NOU8:
v_pk_add_f32 v[60:61], v[96:97], v[98:99]
v_pk_add_f32 v[62:63], v[100:101], v[102:103]
v_pk_add_f32 v[60:61], v[60:61], v[104:105]
v_pk_add_f32 v[62:63], v[62:63], v[106:107]
v_pk_add_f32 v[60:61], v[60:61], v[108:109]
v_pk_add_f32 v[62:63], v[62:63], v[110:111]
v_pk_add_f32 v[60:61], v[60:61], v[62:63]
v_add_f32 v60, v60, v61
v_mov_b32 v61, v60
s_nop 1
v_permlane32_swap_b32 v60, v61
v_add_f32 v62, v60, v61
v_mul_f32 v60, 0x3d000000, v62
v_pk_add_f32 v[64:65], v[96:97], v[60:61] op_sel_hi:[1,0] neg_lo:[0,1] neg_hi:[0,1]
v_pk_add_f32 v[66:67], v[98:99], v[60:61] op_sel_hi:[1,0] neg_lo:[0,1] neg_hi:[0,1]
v_pk_add_f32 v[68:69], v[100:101], v[60:61] op_sel_hi:[1,0] neg_lo:[0,1] neg_hi:[0,1]
v_pk_add_f32 v[70:71], v[102:103], v[60:61] op_sel_hi:[1,0] neg_lo:[0,1] neg_hi:[0,1]
v_pk_add_f32 v[72:73], v[104:105], v[60:61] op_sel_hi:[1,0] neg_lo:[0,1] neg_hi:[0,1]
v_pk_add_f32 v[74:75], v[106:107], v[60:61] op_sel_hi:[1,0] neg_lo:[0,1] neg_hi:[0,1]
v_pk_add_f32 v[76:77], v[108:109], v[60:61] op_sel_hi:[1,0] neg_lo:[0,1] neg_hi:[0,1]
v_pk_add_f32 v[78:79], v[110:111], v[60:61] op_sel_hi:[1,0] neg_lo:[0,1] neg_hi:[0,1]
v_pk_mul_f32 v[60:61], v[64:65], v[64:65]
v_pk_fma_f32 v[60:61], v[66:67], v[66:67], v[60:61]
v_pk_fma_f32 v[60:61], v[68:69], v[68:69], v[60:61]
v_pk_fma_f32 v[60:61], v[70:71], v[70:71], v[60:61]
v_pk_fma_f32 v[60:61], v[72:73], v[72:73], v[60:61]
v_pk_fma_f32 v[60:61], v[74:75], v[74:75], v[60:61]
v_pk_fma_f32 v[60:61], v[76:77], v[76:77], v[60:61]
v_pk_fma_f32 v[60:61], v[78:79], v[78:79], v[60:61]
v_add_f32 v60, v60, v61
v_mov_b32 v61, v60
s_nop 1
v_permlane32_swap_b32 v60, v61
v_add_f32 v63, v60, v61
v_mul_f32 v62, s46, v62
v_mul_f32 v63, s46, v63
s_lshl_b32 s56, s44, 8
v_add_u32 v60, s56, v21
ds_write_b64 v60, v[62:63] offset:18432
s_cmp_eq_u32 s44, 4
s_cbranch_scc1 P1_G_NOXF
v_mov_b32 v56, 163832
v_mov_b32 v57, 1
s_waitcnt vmcnt(0)
s_mov_b64 exec, 1
ds_add_rtn_u32 v57, v56, v57
s_mov_b64 exec, -1
s_lshl_b32 s56, s3, 6
s_add_u32 s56, s56, s62
s_lshl_b32 s56, s56, 7
s_add_u32 s56, s56, 21495808
s_waitcnt lgkmcnt(0)
v_readfirstlane_b32 s57, v57
s_cmp_eq_u32 s57, 7
s_cbranch_scc0 P1_G_NOXF
v_mov_b32 v59, s77
v_lshrrev_b32 v58, 2, v10
s_mov_b64 exec, 0xffffffff
buffer_store_dword v59, v58, s[64:67], s56 offen sc1
s_mov_b64 exec, -1
P1_G_NOXF:
s_waitcnt lgkmcnt(0)
s_cmp_eq_u32 s39, s44
s_mov_b32 s44, 4
s_cbranch_scc1 P1_G1
s_barrier
ds_read_b64 v[60:61], v21 offset:18432
ds_read_b64 v[62:63], v21 offset:18688
ds_read_b64 v[64:65], v21 offset:18944
ds_read_b64 v[66:67], v21 offset:19200
ds_read_b64 v[68:69], v21 offset:19456
s_waitcnt lgkmcnt(0)
v_pk_add_f32 v[44:45], v[60:61], v[62:63]
v_pk_add_f32 v[46:47], v[64:65], v[66:67]
v_pk_add_f32 v[44:45], v[44:45], v[68:69]
v_pk_add_f32 v[44:45], v[44:45], v[46:47]
v_mul_f32 v44, 0x3be38e39, v44
v_fmac_f32 v60, 0xc1800000, v44
v_fmac_f32 v62, 0xc2000000, v44
v_fmac_f32 v64, 0xc2000000, v44
v_fmac_f32 v66, 0xc2000000, v44
v_fmac_f32 v68, 0xc2000000, v44
v_mul_f32 v46, v60, v60
v_mul_f32 v47, v62, v62
v_fmac_f32 v47, v64, v64
v_fmac_f32 v47, v66, v66
v_fmac_f32 v47, v68, v68
v_fmac_f32 v45, 0x3d800000, v46
v_fmac_f32 v45, 0x3d000000, v47
v_mov_b32 v46, 0x3727c5ac
v_fmac_f32 v46, 0x3be38e39, v45
v_rsq_f32 v46, v46
s_mul_i32 s58, s3, 127
s_add_u32 s58, s58, s79
s_mul_i32 s58, s58, 9216
s_add_u32 s58, s58, 16655104
s_cmp_ge_u32 s79, 125
s_cbranch_scc1 P1_DONE
s_and_b32 s44, s76, 3
s_cmp_eq_u32 s39, 99
s_cselect_b32 s44, s44, 4
P1_G2:
v_pk_add_f32 v[96:97], v[96:97], v[44:45] op_sel_hi:[1,0] neg_lo:[0,1] neg_hi:[0,1]
v_pk_add_f32 v[98:99], v[98:99], v[44:45] op_sel_hi:[1,0] neg_lo:[0,1] neg_hi:[0,1]
v_pk_add_f32 v[100:101], v[100:101], v[44:45] op_sel_hi:[1,0] neg_lo:[0,1] neg_hi:[0,1]
v_pk_add_f32 v[102:103], v[102:103], v[44:45] op_sel_hi:[1,0] neg_lo:[0,1] neg_hi:[0,1]
v_pk_add_f32 v[104:105], v[104:105], v[44:45] op_sel_hi:[1,0] neg_lo:[0,1] neg_hi:[0,1]
v_pk_add_f32 v[106:107], v[106:107], v[44:45] op_sel_hi:[1,0] neg_lo:[0,1] neg_hi:[0,1]
v_pk_add_f32 v[108:109], v[108:109], v[44:45] op_sel_hi:[1,0] neg_lo:[0,1] neg_hi:[0,1]
v_pk_add_f32 v[110:111], v[110:111], v[44:45] op_sel_hi:[1,0] neg_lo:[0,1] neg_hi:[0,1]
v_pk_mul_f32 v[96:97], v[96:97], v[46:47] op_sel_hi:[1,0]
v_pk_mul_f32 v[98:99], v[98:99], v[46:47] op_sel_hi:[1,0]
v_pk_mul_f32 v[100:101], v[100:101], v[46:47] op_sel_hi:[1,0]
v_pk_mul_f32 v[102:103], v[102:103], v[46:47] op_sel_hi:[1,0]
v_pk_mul_f32 v[104:105], v[104:105], v[46:47] op_sel_hi:[1,0]
v_pk_mul_f32 v[106:107], v[106:107], v[46:47] op_sel_hi:[1,0]
v_pk_mul_f32 v[108:109], v[108:109], v[46:47] op_sel_hi:[1,0]
v_pk_mul_f32 v[110:111], v[110:111], v[46:47] op_sel_hi:[1,0]
v_cvt_pk_bf16_f32 v72, v96, v97
v_cvt_pk_bf16_f32 v73, v98, v99
v_cvt_pk_bf16_f32 v74, v100, v101
v_cvt_pk_bf16_f32 v75, v102, v103
v_cvt_pk_bf16_f32 v76, v104, v105
v_cvt_pk_bf16_f32 v77, v106, v107
v_cvt_pk_bf16_f32 v78, v108, v109
v_cvt_pk_bf16_f32 v79, v110, v111
ds_write_b128 v5, v[72:75]
ds_write_b128 v5, v[76:79] offset:32
s_waitcnt lgkmcnt(0)
ds_read_b64_tr_b16 v[80:81], v4 offset:0
ds_read_b64_tr_b16 v[82:83], v4 offset:320
ds_read_b64_tr_b16 v[84:85], v4 offset:640
ds_read_b64_tr_b16 v[86:87], v4 offset:960
s_lshl_b32 s56, s44, 9
s_add_u32 s59, s58, s56
v_mov_b32 v96, v24
v_mov_b32 v97, v25
v_mov_b32 v98, v26
v_mov_b32 v99, v27
v_mov_b32 v100, v28
v_mov_b32 v101, v29
v_mov_b32 v102, v30
v_mov_b32 v103, v31
v_mov_b32 v104, v32
v_mov_b32 v105, v33
v_mov_b32 v106, v34
v_mov_b32 v107, v35
v_mov_b32 v108, v36
v_mov_b32 v109, v37
v_mov_b32 v110, v38
v_mov_b32 v111, v39
s_cmp_eq_u32 s44, 4
s_cbranch_scc0 P1_G3
s_waitcnt lgkmcnt(0)
buffer_store_dwordx4 v[80:83], v7, s[64:67], s59 offen sc1
buffer_store_dwordx4 v[84:87], v7, s[64:67], s59 offen offset:2304 sc1
s_mov_b32 s44, s39
s_branch P1_G2
P1_G3:
s_mov_b32 s8, s59
s_add_u32 s9, s59, 2304
s_cmp_eq_u32 s44, 0
s_cselect_b32 s10, 0, -1
v_mov_b32 v98, v7
s_waitcnt lgkmcnt(0)
v_mov_b32 v104, v80
v_mov_b32 v105, v81
v_mov_b32 v106, v82
v_mov_b32 v107, v83
v_mov_b32 v108, v84
v_mov_b32 v109, v85
v_mov_b32 v110, v86
v_mov_b32 v111, v87
s_branch P1_DONE
P1_WTYPE:
v_lshrrev_b32 v44, 5, v1
v_bfe_u32 v45, v1, 2, 2
v_lshl_add_u32 v44, v44, 3, v45
v_mul_u32_u24 v44, 288, v44
v_bfe_u32 v45, v1, 4, 1
v_lshl_add_u32 v44, v45, 5, v44
v_and_b32 v45, 1, v1
v_lshl_add_u32 v44, v45, 4, v44
v_bfe_u32 v45, v1, 1, 1
v_lshl_add_u32 v11, v45, 3, v44
s_cmp_eq_u32 s46, 3
s_cbranch_scc1 P1_W_DN
s_cmp_ge_u32 s59, 5
s_cbranch_scc1 P1_W_CHORES
s_waitcnt vmcnt(6)
s_barrier
s_and_b32 s44, s76, 3
P1_W1:
s_lshl_b32 s56, s44, 6
s_add_u32 s56, s56, 36864
v_add_u32 v3, s56, v11
ds_read_b64_tr_b16 a[0:1], v3 offset:0
ds_read_b64_tr_b16 a[2:3], v3 offset:1152
ds_read_b64_tr_b16 a[4:5], v3 offset:4608
ds_read_b64_tr_b16 a[6:7], v3 offset:5760
ds_read_b64_tr_b16 a[8:9], v3 offset:9216
ds_read_b64_tr_b16 a[10:11], v3 offset:10368
ds_read_b64_tr_b16 a[12:13], v3 offset:13824
ds_read_b64_tr_b16 a[14:15], v3 offset:14976
ds_read_b64_tr_b16 a[16:17], v3 offset:18432
ds_read_b64_tr_b16 a[18:19], v3 offset:19584
ds_read_b64_tr_b16 a[20:21], v3 offset:23040
ds_read_b64_tr_b16 a[22:23], v3 offset:24192
ds_read_b64_tr_b16 a[24:25], v3 offset:27648
ds_read_b64_tr_b16 a[26:27], v3 offset:28800
s_waitcnt lgkmcnt(12)
v_mfma_f32_32x32x16_bf16 v[24:39], a[0:3], v[60:63], 0
ds_read_b64_tr_b16 a[28:29], v3 offset:32256
ds_read_b64_tr_b16 a[30:31], v3 offset:33408
s_waitcnt lgkmcnt(12)
v_mfma_f32_32x32x16_bf16 v[24:39], a[4:7], v[64:67], v[24:39]
ds_read_b64_tr_b16 a[0:1], v3 offset:36864
ds_read_b64_tr_b16 a[2:3], v3 offset:38016
s_waitcnt lgkmcnt(12)
v_mfma_f32_32x32x16_bf16 v[24:39], a[8:11], v[68:71], v[24:39]
s_waitcnt lgkmcnt(10)
v_mfma_f32_32x32x16_bf16 v[24:39], a[12:15], v[72:75], v[24:39]
s_waitcnt lgkmcnt(8)
v_mfma_f32_32x32x16_bf16 v[24:39], a[16:19], v[76:79], v[24:39]
s_waitcnt lgkmcnt(6)
v_mfma_f32_32x32x16_bf16 v[24:39], a[20:23], v[80:83], v[24:39]
s_waitcnt lgkmcnt(4)
v_mfma_f32_32x32x16_bf16 v[24:39], a[24:27], v[84:87], v[24:39]
s_waitcnt lgkmcnt(2)
v_mfma_f32_32x32x16_bf16 v[24:39], a[28:31], v[88:91], v[24:39]
s_waitcnt lgkmcnt(0)
v_mfma_f32_32x32x16_bf16 v[24:39], a[0:3], v[92:95], v[24:39]
s_nop 11
v_cvt_pk_bf16_f32 v44, v24, v25
v_cvt_pk_bf16_f32 v45, v26, v27
v_cvt_pk_bf16_f32 v46, v28, v29
v_cvt_pk_bf16_f32 v47, v30, v31
v_cvt_pk_bf16_f32 v48, v32, v33
v_cvt_pk_bf16_f32 v49, v34, v35
v_cvt_pk_bf16_f32 v50, v36, v37
v_cvt_pk_bf16_f32 v51, v38, v39
s_lshl_b32 s56, s44, 11
v_add_u32 v6, s56, v8
ds_write_b128 v6, v[44:47] offset:18432
s_cmp_eq_u32 s44, 4
s_cbranch_scc1 P1_W1W
ds_write_b128 v6, v[48:51] offset:19456
P1_W1W:
s_waitcnt lgkmcnt(0)
s_cmp_eq_u32 s39, s44
s_mov_b32 s44, 4
s_cbranch_scc1 P1_W1
s_waitcnt vmcnt(0)
s_barrier
s_and_b32 s44, s76, 3
P1_W2:
s_lshl_b32 s56, s44, 6
s_add_u32 s56, s56, 78848
v_add_u32 v3, s56, v11
ds_read_b128 v[60:63], v8 offset:18432
ds_read_b64_tr_b16 a[0:1], v3 offset:0
ds_read_b64_tr_b16 a[2:3], v3 offset:1152
ds_read_b128 v[64:67], v8 offset:19456
ds_read_b64_tr_b16 a[4:5], v3 offset:4608
ds_read_b64_tr_b16 a[6:7], v3 offset:5760
ds_read_b128 v[68:71], v8 offset:20480
ds_read_b64_tr_b16 a[8:9], v3 offset:9216
ds_read_b64_tr_b16 a[10:11], v3 offset:10368
ds_read_b128 v[72:75], v8 offset:21504
ds_read_b64_tr_b16 a[12:13], v3 offset:13824
ds_read_b64_tr_b16 a[14:15], v3 offset:14976
ds_read_b128 v[76:79], v8 offset:22528
ds_read_b64_tr_b16 a[16:17], v3 offset:18432
ds_read_b64_tr_b16 a[18:19], v3 offset:19584
s_waitcnt lgkmcnt(12)
v_mfma_f32_32x32x16_bf16 v[24:39], v[60:63], a[0:3], 0
ds_read_b128 v[80:83], v8 offset:23552
ds_read_b64_tr_b16 a[20:21], v3 offset:23040
ds_read_b64_tr_b16 a[22:23], v3 offset:24192
s_waitcnt lgkmcnt(12)
v_mfma_f32_32x32x16_bf16 v[24:39], v[64:67], a[4:7], v[24:39]
ds_read_b128 v[84:87], v8 offset:24576
ds_read_b64_tr_b16 a[24:25], v3 offset:27648
ds_read_b64_tr_b16 a[26:27], v3 offset:28800
s_waitcnt lgkmcnt(12)
v_mfma_f32_32x32x16_bf16 v[24:39], v[68:71], a[8:11], v[24:39]
ds_read_b128 v[88:91], v8 offset:25600
ds_read_b64_tr_b16 a[28:29], v3 offset:32256
ds_read_b64_tr_b16 a[30:31], v3 offset:33408
s_waitcnt lgkmcnt(12)
v_mfma_f32_32x32x16_bf16 v[24:39], v[72:75], a[12:15], v[24:39]
ds_read_b128 v[92:95], v8 offset:26624
ds_read_b64_tr_b16 a[0:1], v3 offset:36864
ds_read_b64_tr_b16 a[2:3], v3 offset:38016
s_waitcnt lgkmcnt(12)
v_mfma_f32_32x32x16_bf16 v[24:39], v[76:79], a[16:19], v[24:39]
s_waitcnt lgkmcnt(9)
v_mfma_f32_32x32x16_bf16 v[24:39], v[80:83], a[20:23], v[24:39]
s_waitcnt lgkmcnt(6)
v_mfma_f32_32x32x16_bf16 v[24:39], v[84:87], a[24:27], v[24:39]
s_waitcnt lgkmcnt(3)
v_mfma_f32_32x32x16_bf16 v[24:39], v[88:91], a[28:31], v[24:39]
s_waitcnt lgkmcnt(0)
v_mfma_f32_32x32x16_bf16 v[24:39], v[92:95], a[0:3], v[24:39]
s_nop 11
v_cvt_pk_bf16_f32 v44, v24, v25
v_cvt_pk_bf16_f32 v45, v26, v27
v_cvt_pk_bf16_f32 v46, v28, v29
v_cvt_pk_bf16_f32 v47, v30, v31
v_cvt_pk_bf16_f32 v48, v32, v33
v_cvt_pk_bf16_f32 v49, v34, v35
v_cvt_pk_bf16_f32 v50, v36, v37
v_cvt_pk_bf16_f32 v51, v38, v39
s_lshl_b32 s56, s59, 1
s_cmp_eq_u32 s44, 4
s_cbranch_scc1 P1_WSA_T4
s_mul_i32 s57, s44, 9
s_add_u32 s57, s57, s56
s_lshl_b32 s57, s57, 10
s_add_u32 s57, s57, 19070976
buffer_store_dwordx4 v[44:47], v10, s[64:67], s57 offen sc1
s_cmp_eq_u32 s56, 8
s_cbranch_scc1 P1_WSA_E
buffer_store_dwordx4 v[48:51], v10, s[64:67], s57 offen offset:1024 sc1
s_branch P1_WSA_E
P1_WSA_T4:
s_lshl_b32 s57, s56, 9
s_add_u32 s57, s57, 19107840
v_and_b32 v52, 15, v1
v_lshrrev_b32 v53, 5, v1
v_lshl_add_u32 v52, v53, 4, v52
v_lshlrev_b32 v52, 4, v52
s_mov_b32 exec_lo, 0xffff
s_mov_b32 exec_hi, 0xffff
buffer_store_dwordx4 v[44:47], v52, s[64:67], s57 offen sc1
s_cmp_eq_u32 s56, 8
s_cbranch_scc1 P1_WSA_X
buffer_store_dwordx4 v[48:51], v52, s[64:67], s57 offen offset:512 sc1
P1_WSA_X:
s_mov_b64 exec, -1
P1_WSA_E:
s_cmp_eq_u32 s39, s44
s_mov_b32 s44, 4
s_cbranch_scc1 P1_W2
s_branch P1_WDONE
P1_W_CHORES:
s_and_b32 s44, s76, 3
s_cmp_ge_u32 s44, 3
s_cbranch_scc1 P1_W_CH2
s_lshl_b32 s56, s44, 6
v_add_u32 v44, s56, v1
v_lshlrev_b32 v45, 1, v44
v_add_u32 v46, 4032, v45
v_add_u32 v47, 8064, v45
v_mul_u32_u24 v48, 80, v44
v_cmp_gt_u32 vcc, 144, v44
v_mov_b32 v12, 0
v_mov_b32 v13, 0
v_mov_b32 v30, 0
v_mov_b32 v31, 0
s_and_saveexec_b64 s[58:59], vcc
buffer_load_ushort v60, v45, s[92:95], 0 offen offset:0
buffer_load_ushort v61, v45, s[92:95], 0 offen offset:288
buffer_load_ushort v62, v45, s[92:95], 0 offen offset:576
buffer_load_ushort v63, v45, s[92:95], 0 offen offset:864
buffer_load_ushort v64, v45, s[92:95], 0 offen offset:1152
buffer_load_ushort v65, v45, s[92:95], 0 offen offset:1440
buffer_load_ushort v66, v45, s[92:95], 0 offen offset:1728
buffer_load_ushort v67, v45, s[92:95], 0 offen offset:2016
buffer_load_ushort v68, v45, s[92:95], 0 offen offset:2304
buffer_load_ushort v69, v45, s[92:95], 0 offen offset:2592
buffer_load_ushort v70, v45, s[92:95], 0 offen offset:2880
buffer_load_ushort v71, v45, s[92:95], 0 offen offset:3168
buffer_load_ushort v72, v45, s[92:95], 0 offen offset:3456
buffer_load_ushort v73, v45, s[92:95], 0 offen offset:3744
buffer_load_ushort v74, v46, s[92:95], 0 offen offset:0
buffer_load_ushort v75, v46, s[92:95], 0 offen offset:288
buffer_load_ushort v76, v46, s[92:95], 0 offen offset:576
buffer_load_ushort v77, v46, s[92:95], 0 offen offset:864
buffer_load_ushort v78, v46, s[92:95], 0 offen offset:1152
buffer_load_ushort v79, v46, s[92:95], 0 offen offset:1440
buffer_load_ushort v80, v46, s[92:95], 0 offen offset:1728
buffer_load_ushort v81, v46, s[92:95], 0 offen offset:2016
buffer_load_ushort v82, v46, s[92:95], 0 offen offset:2304
buffer_load_ushort v83, v46, s[92:95], 0 offen offset:2592
buffer_load_ushort v84, v46, s[92:95], 0 offen offset:2880
buffer_load_ushort v85, v46, s[92:95], 0 offen offset:3168
buffer_load_ushort v86, v46, s[92:95], 0 offen offset:3456
buffer_load_ushort v87, v46, s[92:95], 0 offen offset:3744
buffer_load_ushort v88, v47, s[92:95], 0 offen offset:0
buffer_load_ushort v89, v47, s[92:95], 0 offen offset:288
buffer_load_ushort v90, v47, s[92:95], 0 offen offset:576
s_mov_b32 s46, 19161600
s_waitcnt vmcnt(0)
s_barrier
v_lshl_or_b32 v14, v61, 16, v60
v_lshl_or_b32 v15, v63, 16, v62
v_lshl_or_b32 v16, v65, 16, v64
v_lshl_or_b32 v17, v67, 16, v66
v_lshl_or_b32 v18, v69, 16, v68
v_lshl_or_b32 v19, v71, 16, v70
v_lshl_or_b32 v20, v73, 16, v72
v_lshl_or_b32 v21, v75, 16, v74
v_lshl_or_b32 v22, v77, 16, v76
v_lshl_or_b32 v23, v79, 16, v78
v_lshl_or_b32 v24, v81, 16, v80
v_lshl_or_b32 v25, v83, 16, v82
v_lshl_or_b32 v26, v85, 16, v84
v_lshl_or_b32 v27, v87, 16, v86
v_lshl_or_b32 v28, v89, 16, v88
v_mov_b32 v29, v90
buffer_store_dwordx4 v[12:15], v48, s[64:67], s46 offen offset:0 sc1
buffer_store_dwordx4 v[16:19], v48, s[64:67], s46 offen offset:16 sc1
buffer_store_dwordx4 v[20:23], v48, s[64:67], s46 offen offset:32 sc1
buffer_store_dwordx4 v[24:27], v48, s[64:67], s46 offen offset:48 sc1
buffer_store_dwordx4 v[28:31], v48, s[64:67], s46 offen offset:64 sc1
s_mov_b64 exec, -1
s_barrier
s_branch P1_DONE
P1_W_CH2:
v_mov_b32 v60, 0
v_mov_b32 v61, 0
v_mov_b32 v62, 0
v_mov_b32 v63, 0
s_waitcnt vmcnt(0)
s_barrier
s_mov_b32 s59, 16650752
buffer_store_dwordx4 v[60:63], v10, s[64:67], s59 offen offset:0 sc1
buffer_store_dwordx4 v[60:63], v10, s[64:67], s59 offen offset:1024 sc1
buffer_store_dwordx4 v[60:63], v10, s[64:67], s59 offen offset:2048 sc1
buffer_store_dwordx4 v[60:63], v10, s[64:67], s59 offen offset:3072 sc1
s_mov_b32 s59, 16654336
buffer_store_dwordx4 v[60:63], v10, s[64:67], s59 offen sc1
s_mov_b32 s59, 17807360
buffer_store_dwordx4 v[60:63], v10, s[64:67], s59 offen offset:0 sc1
buffer_store_dwordx4 v[60:63], v10, s[64:67], s59 offen offset:1024 sc1
buffer_store_dwordx4 v[60:63], v10, s[64:67], s59 offen offset:2048 sc1
buffer_store_dwordx4 v[60:63], v10, s[64:67], s59 offen offset:3072 sc1
s_mov_b32 s59, 17810944
buffer_store_dwordx4 v[60:63], v10, s[64:67], s59 offen sc1
s_mov_b32 s59, 17821184
buffer_store_dwordx4 v[60:63], v10, s[64:67], s59 offen offset:0 sc1
buffer_store_dwordx4 v[60:63], v10, s[64:67], s59 offen offset:1024 sc1
buffer_store_dwordx4 v[60:63], v10, s[64:67], s59 offen offset:2048 sc1
buffer_store_dwordx4 v[60:63], v10, s[64:67], s59 offen offset:3072 sc1
s_mov_b32 s59, 17824768
buffer_store_dwordx4 v[60:63], v10, s[64:67], s59 offen sc1
s_mov_b32 s59, 18977792
buffer_store_dwordx4 v[60:63], v10, s[64:67], s59 offen offset:0 sc1
buffer_store_dwordx4 v[60:63], v10, s[64:67], s59 offen offset:1024 sc1
buffer_store_dwordx4 v[60:63], v10, s[64:67], s59 offen offset:2048 sc1
buffer_store_dwordx4 v[60:63], v10, s[64:67], s59 offen offset:3072 sc1
s_mov_b32 s59, 18981376
buffer_store_dwordx4 v[60:63], v10, s[64:67], s59 offen sc1
s_barrier
s_branch P1_DONE
P1_W_DN:
s_mov_b32 s59, s43
s_add_u32 s57, s45, 36864
v_add_u32 v7, s57, v7
s_waitcnt vmcnt(0)
s_barrier
P1_W_DNL:
s_and_b32 s44, s76, 3
P1_W3:
s_lshl_b32 s56, s44, 6
s_add_u32 s56, s56, 78848
v_add_u32 v3, s56, v11
ds_read_b128 v[60:63], v7 offset:0
ds_read_b64_tr_b16 a[0:1], v3 offset:0
ds_read_b64_tr_b16 a[2:3], v3 offset:1152
ds_read_b128 v[64:67], v7 offset:32
ds_read_b64_tr_b16 a[4:5], v3 offset:4608
ds_read_b64_tr_b16 a[6:7], v3 offset:5760
ds_read_b128 v[68:71], v7 offset:64
ds_read_b64_tr_b16 a[8:9], v3 offset:9216
ds_read_b64_tr_b16 a[10:11], v3 offset:10368
ds_read_b128 v[72:75], v7 offset:96
ds_read_b64_tr_b16 a[12:13], v3 offset:13824
ds_read_b64_tr_b16 a[14:15], v3 offset:14976
ds_read_b128 v[76:79], v7 offset:128
ds_read_b64_tr_b16 a[16:17], v3 offset:18432
ds_read_b64_tr_b16 a[18:19], v3 offset:19584
s_waitcnt lgkmcnt(12)
v_mfma_f32_32x32x16_bf16 v[24:39], v[60:63], a[0:3], 0
ds_read_b128 v[80:83], v7 offset:160
ds_read_b64_tr_b16 a[20:21], v3 offset:23040
ds_read_b64_tr_b16 a[22:23], v3 offset:24192
s_waitcnt lgkmcnt(12)
v_mfma_f32_32x32x16_bf16 v[24:39], v[64:67], a[4:7], v[24:39]
ds_read_b128 v[84:87], v7 offset:192
ds_read_b64_tr_b16 a[24:25], v3 offset:27648
ds_read_b64_tr_b16 a[26:27], v3 offset:28800
s_waitcnt lgkmcnt(12)
v_mfma_f32_32x32x16_bf16 v[24:39], v[68:71], a[8:11], v[24:39]
ds_read_b128 v[88:91], v7 offset:224
ds_read_b64_tr_b16 a[28:29], v3 offset:32256
ds_read_b64_tr_b16 a[30:31], v3 offset:33408
s_waitcnt lgkmcnt(12)
v_mfma_f32_32x32x16_bf16 v[24:39], v[72:75], a[12:15], v[24:39]
ds_read_b128 v[92:95], v7 offset:256
ds_read_b64_tr_b16 a[0:1], v3 offset:36864
ds_read_b64_tr_b16 a[2:3], v3 offset:38016
s_waitcnt lgkmcnt(12)
v_mfma_f32_32x32x16_bf16 v[24:39], v[76:79], a[16:19], v[24:39]
s_waitcnt lgkmcnt(9)
v_mfma_f32_32x32x16_bf16 v[24:39], v[80:83], a[20:23], v[24:39]
s_waitcnt lgkmcnt(6)
v_mfma_f32_32x32x16_bf16 v[24:39], v[84:87], a[24:27], v[24:39]
s_waitcnt lgkmcnt(3)
v_mfma_f32_32x32x16_bf16 v[24:39], v[88:91], a[28:31], v[24:39]
s_waitcnt lgkmcnt(0)
v_mfma_f32_32x32x16_bf16 v[24:39], v[92:95], a[0:3], v[24:39]
s_nop 11
v_cvt_pk_bf16_f32 v44, v24, v25
v_cvt_pk_bf16_f32 v45, v26, v27
v_cvt_pk_bf16_f32 v46, v28, v29
v_cvt_pk_bf16_f32 v47, v30, v31
v_cvt_pk_bf16_f32 v48, v32, v33
v_cvt_pk_bf16_f32 v49, v34, v35
v_cvt_pk_bf16_f32 v50, v36, v37
v_cvt_pk_bf16_f32 v51, v38, v39
s_lshl_b32 s56, s59, 1
s_cmp_eq_u32 s44, 4
s_cbranch_scc1 P1_WSC_T4
s_mul_i32 s57, s44, 9
s_add_u32 s57, s57, s56
s_lshl_b32 s57, s57, 10
s_add_u32 s57, s57, 19120128
buffer_store_dwordx4 v[44:47], v10, s[64:67], s57 offen sc1
s_cmp_eq_u32 s56, 8
s_cbranch_scc1 P1_WSC_E
buffer_store_dwordx4 v[48:51], v10, s[64:67], s57 offen offset:1024 sc1
s_branch P1_WSC_E
P1_WSC_T4:
s_lshl_b32 s57, s56, 9
s_add_u32 s57, s57, 19156992
v_and_b32 v52, 15, v1
v_lshrrev_b32 v53, 5, v1
v_lshl_add_u32 v52, v53, 4, v52
v_lshlrev_b32 v52, 4, v52
s_mov_b32 exec_lo, 0xffff
s_mov_b32 exec_hi, 0xffff
buffer_store_dwordx4 v[44:47], v52, s[64:67], s57 offen sc1
s_cmp_eq_u32 s56, 8
s_cbranch_scc1 P1_WSC_X
buffer_store_dwordx4 v[48:51], v52, s[64:67], s57 offen offset:512 sc1
P1_WSC_X:
s_mov_b64 exec, -1
P1_WSC_E:
s_cmp_eq_u32 s39, s44
s_mov_b32 s44, 4
s_cbranch_scc1 P1_W3
v_add_u32 v7, 18432, v7
s_add_u32 s59, s59, 2
s_cmp_lt_u32 s59, 5
s_cbranch_scc1 P1_W_DNL
P1_WDONE:
P1_DONE:
s_cmp_eq_u32 s76, 1
s_cbranch_scc0 K2_C1Nz
v_accvgpr_read_b32 v40, a119
buffer_load_dword v16, v40, s[64:67], 0 offen sc1
K2_C1Nz:
v_accvgpr_read_b32 v2, a112
v_accvgpr_read_b32 v3, a113
v_accvgpr_read_b32 v4, a114
v_accvgpr_read_b32 v5, a115
v_accvgpr_read_b32 v6, a116
v_accvgpr_read_b32 v88, a117
v_accvgpr_read_b32 v89, a118
v_accvgpr_read_b32 v90, a119
v_accvgpr_read_b32 v96, a120
v_lshrrev_b32 v11, 2, v10
v_mov_b32 v7, 0
v_mov_b32 v9, 0x5f800000
v_mov_b32 v95, s77
s_waitcnt lgkmcnt(0)
s_cmp_eq_u32 s76, 1
s_cbranch_scc0 K2_C1B_OK
s_waitcnt vmcnt(0)
v_cmp_ne_u32 vcc, s77, v16
s_cbranch_vccz K2_C1B_OK
s_mov_b32 s23, 0
K2_C1B:
buffer_load_dword v80, v90, s[64:67], 0 offen sc1
s_add_u32 s23, s23, 1
s_waitcnt vmcnt(0)
v_cmp_ne_u32 vcc, s77, v80
s_cbranch_vccz K2_C1B_OK
s_sleep 1
s_cmp_lt_u32 s23, 400000
s_cbranch_scc1 K2_C1B
K2_C1B_OK:
s_barrier
s_add_u32 m0, s24, s20
s_add_u32 s19, s18, 4096
buffer_load_dwordx4 v6, s[64:67], s18 offen offset:0 sc1 lds
buffer_load_dwordx4 v6, s[64:67], s18 offen offset:1024 sc1 lds
buffer_load_dwordx4 v6, s[64:67], s18 offen offset:2048 sc1 lds
buffer_load_dwordx4 v6, s[64:67], s18 offen offset:3072 sc1 lds
s_add_u32 m0, m0, 4096
s_mov_b64 exec, 0xffffffff
buffer_load_dwordx4 v6, s[64:67], s19 offen sc1 lds
s_mov_b64 exec, -1
s_add_u32 m0, s26, 64512
s_mov_b32 s18, s41
buffer_load_dwordx4 v89, s[64:67], s18 offen sc1 lds
buffer_load_dwordx4 v89, s[64:67], s18 offen offset:1024 sc1 lds
s_mov_b64 exec, 0xffff
buffer_load_dwordx4 v89, s[64:67], s18 offen offset:2048 sc1 lds
s_mov_b64 exec, -1
s_add_u32 s18, s18, 9216
s_mov_b32 s20, 0
s_barrier
s_add_u32 m0, s24, s20
s_add_u32 s19, s18, 4096
buffer_load_dwordx4 v6, s[64:67], s18 offen offset:0 sc1 lds
buffer_load_dwordx4 v6, s[64:67], s18 offen offset:1024 sc1 lds
buffer_load_dwordx4 v6, s[64:67], s18 offen offset:2048 sc1 lds
buffer_load_dwordx4 v6, s[64:67], s18 offen offset:3072 sc1 lds
s_add_u32 m0, m0, 4096
s_mov_b64 exec, 0xffffffff
buffer_load_dwordx4 v6, s[64:67], s19 offen sc1 lds
s_mov_b64 exec, -1
s_add_u32 s18, s18, 18432
s_add_u32 s20, s20, 18432
s_cmp_ge_u32 s20, 73728
s_cselect_b32 s20, 0, s20
s_cmp_eq_u32 s17, 0
s_cbranch_scc1 K2_IDLE
s_waitcnt vmcnt(5)
s_barrier
ds_read_b128 a[72:75], v88 offset:36864
ds_read_b128 a[108:111], v4 offset:9216
ds_read_b128 a[76:79], v88 offset:37888
ds_read_b128 a[112:115], v4 offset:9248
ds_read_b128 a[80:83], v88 offset:38912
ds_read_b128 a[116:119], v4 offset:9280
ds_read_b128 a[84:87], v88 offset:39936
ds_read_b128 a[120:123], v4 offset:9312
ds_read_b128 a[88:91], v88 offset:40960
ds_read_b128 a[124:127], v4 offset:9344
ds_read_b128 a[92:95], v88 offset:41984
ds_read_b128 a[128:131], v4 offset:9376
ds_read_b128 a[96:99], v88 offset:43008
ds_read_b128 a[100:103], v88 offset:44032
ds_read_b128 a[104:107], v88 offset:45056
s_waitcnt lgkmcnt(13)
v_mfma_f32_32x32x16_bf16 v[16:31], a[108:111], a[72:75], 0
ds_read_b128 a[132:135], v4 offset:9408
s_add_u32 m0, s24, s20
s_add_u32 s19, s18, 4096
buffer_load_dwordx4 v6, s[64:67], s18 offen offset:0 sc1 lds
s_waitcnt lgkmcnt(12)
v_mfma_f32_32x32x16_bf16 v[16:31], a[112:115], a[76:79], v[16:31]
ds_read_b128 a[136:139], v4 offset:9440
buffer_load_dwordx4 v6, s[64:67], s18 offen offset:1024 sc1 lds
s_waitcnt lgkmcnt(11)
v_mfma_f32_32x32x16_bf16 v[16:31], a[116:119], a[80:83], v[16:31]
ds_read_b128 a[140:143], v4 offset:9472
buffer_load_dwordx4 v6, s[64:67], s18 offen offset:2048 sc1 lds
s_waitcnt lgkmcnt(10)
v_mfma_f32_32x32x16_bf16 v[16:31], a[120:123], a[84:87], v[16:31]
buffer_load_dwordx4 v6, s[64:67], s18 offen offset:3072 sc1 lds
s_waitcnt lgkmcnt(8)
v_mfma_f32_32x32x16_bf16 v[16:31], a[124:127], a[88:91], v[16:31]
s_add_u32 m0, m0, 4096
s_mov_b64 exec, 0xffffffff
buffer_load_dwordx4 v6, s[64:67], s19 offen sc1 lds
s_mov_b64 exec, -1
s_add_u32 s18, s18, 18432
s_add_u32 s20, s20, 18432
s_cmp_ge_u32 s20, 73728
s_cselect_b32 s20, 0, s20
s_waitcnt lgkmcnt(6)
v_mfma_f32_32x32x16_bf16 v[16:31], a[128:131], a[92:95], v[16:31]
s_waitcnt lgkmcnt(2)
v_mfma_f32_32x32x16_bf16 v[16:31], a[132:135], a[96:99], v[16:31]
s_waitcnt lgkmcnt(1)
v_mfma_f32_32x32x16_bf16 v[16:31], a[136:139], a[100:103], v[16:31]
s_waitcnt lgkmcnt(0)
v_mfma_f32_32x32x16_bf16 v[16:31], a[140:143], a[104:107], v[16:31]
s_waitcnt vmcnt(5)
s_barrier
s_cmp_eq_u32 s8, 0
s_cbranch_scc1 K2_NDSa
s_mov_b32 exec_lo, s10
buffer_store_dwordx4 v[104:107], v98, s[64:67], s8 offen sc1
buffer_store_dwordx4 v[108:111], v98, s[64:67], s9 offen sc1
s_mov_b64 exec, -1
K2_NDSa:
s_nop 1
v_add_u32 v4, s22, v2
ds_read_b128 a[108:111], v4 offset:0
ds_read_b128 a[112:115], v4 offset:32
ds_read_b128 a[116:119], v4 offset:64
ds_read_b128 a[120:123], v4 offset:96
ds_read_b128 a[124:127], v4 offset:128
ds_read_b128 a[128:131], v4 offset:160
v_max3_f32 v88, v16, v17, v18
v_max3_f32 v88, v88, v19, v20
v_max3_f32 v88, v88, v21, v22
v_max3_f32 v88, v88, v23, v24
v_max3_f32 v88, v88, v25, v26
v_max3_f32 v88, v88, v27, v28
v_max3_f32 v88, v88, v29, v30
v_max_f32 v88, v88, v31
v_mov_b32 v89, v88
s_nop 1
v_permlane32_swap_b32 v88, v89
v_max_f32 v88, v88, v89
v_sub_f32 v48, 0, v88
v_sub_f32 v49, 0, v88
v_sub_f32 v50, 0, v88
v_sub_f32 v51, 0, v88
v_sub_f32 v52, 0, v88
v_sub_f32 v53, 0, v88
v_sub_f32 v54, 0, v88
v_sub_f32 v55, 0, v88
v_sub_f32 v56, 0, v88
v_sub_f32 v57, 0, v88
v_sub_f32 v58, 0, v88
v_sub_f32 v59, 0, v88
v_sub_f32 v60, 0, v88
v_sub_f32 v61, 0, v88
v_sub_f32 v62, 0, v88
v_sub_f32 v63, 0, v88
v_sub_f32 v16, v16, v88
v_sub_f32 v17, v17, v88
v_sub_f32 v18, v18, v88
v_sub_f32 v19, v19, v88
v_sub_f32 v20, v20, v88
v_sub_f32 v21, v21, v88
v_sub_f32 v22, v22, v88
v_sub_f32 v23, v23, v88
v_sub_f32 v24, v24, v88
v_sub_f32 v25, v25, v88
v_sub_f32 v26, v26, v88
v_sub_f32 v27, v27, v88
v_sub_f32 v28, v28, v88
v_sub_f32 v29, v29, v88
v_sub_f32 v30, v30, v88
v_sub_f32 v31, v31, v88
s_waitcnt lgkmcnt(5)
v_mfma_f32_32x32x16_bf16 v[32:47], a[108:111], a[72:75], v[48:63]
ds_read_b128 a[132:135], v4 offset:192
v_exp_f32 v80, v16
v_exp_f32 v81, v17
v_add_f32 v8, v7, v80
v_cvt_pk_bf16_f32 v64, v80, v81
v_add_f32 v8, v8, v81
s_waitcnt lgkmcnt(5)
v_mfma_f32_32x32x16_bf16 v[32:47], a[112:115], a[76:79], v[32:47]
ds_read_b128 a[136:139], v4 offset:224
v_exp_f32 v82, v24
v_exp_f32 v83, v25
v_add_f32 v8, v8, v82
v_cvt_pk_bf16_f32 v68, v82, v83
v_add_f32 v8, v8, v83
s_waitcnt lgkmcnt(5)
v_mfma_f32_32x32x16_bf16 v[32:47], a[116:119], a[80:83], v[32:47]
ds_read_b128 a[140:143], v4 offset:256
v_exp_f32 v84, v18
v_exp_f32 v85, v19
v_permlane16_swap_b32 v64, v68
v_add_f32 v8, v8, v84
v_cvt_pk_bf16_f32 v65, v84, v85
s_waitcnt lgkmcnt(5)
v_mfma_f32_32x32x16_bf16 v[32:47], a[120:123], a[84:87], v[32:47]
ds_read_b64_tr_b16 a[108:109], v5 offset:9216
ds_read_b64_tr_b16 a[110:111], v5 offset:11520
v_add_f32 v8, v8, v85
v_exp_f32 v86, v26
v_exp_f32 v87, v27
v_add_f32 v8, v8, v86
v_cvt_pk_bf16_f32 v69, v86, v87
s_waitcnt lgkmcnt(6)
v_mfma_f32_32x32x16_bf16 v[32:47], a[124:127], a[88:91], v[32:47]
ds_read_b64_tr_b16 a[112:113], v5 offset:9248
ds_read_b64_tr_b16 a[114:115], v5 offset:11552
v_add_f32 v8, v8, v87
v_exp_f32 v80, v20
v_exp_f32 v81, v21
v_permlane16_swap_b32 v65, v69
s_waitcnt lgkmcnt(7)
v_mfma_f32_32x32x16_bf16 v[32:47], a[128:131], a[92:95], v[32:47]
ds_read_b64_tr_b16 a[116:117], v5 offset:9280
ds_read_b64_tr_b16 a[118:119], v5 offset:11584
v_add_f32 v8, v8, v80
v_cvt_pk_bf16_f32 v66, v80, v81
v_add_f32 v8, v8, v81
v_exp_f32 v82, v28
v_exp_f32 v83, v29
s_waitcnt lgkmcnt(8)
v_mfma_f32_32x32x16_bf16 v[32:47], a[132:135], a[96:99], v[32:47]
ds_read_b64_tr_b16 a[120:121], v5 offset:9312
ds_read_b64_tr_b16 a[122:123], v5 offset:11616
v_add_f32 v8, v8, v82
v_cvt_pk_bf16_f32 v70, v82, v83
v_add_f32 v8, v8, v83
v_exp_f32 v84, v22
v_exp_f32 v85, v23
s_waitcnt lgkmcnt(9)
v_mfma_f32_32x32x16_bf16 v[32:47], a[136:139], a[100:103], v[32:47]
ds_read_b64_tr_b16 a[124:125], v5 offset:9344
ds_read_b64_tr_b16 a[126:127], v5 offset:11648
v_permlane16_swap_b32 v66, v70
v_add_f32 v8, v8, v84
v_cvt_pk_bf16_f32 v67, v84, v85
v_add_f32 v8, v8, v85
v_exp_f32 v86, v30
s_waitcnt lgkmcnt(10)
v_mfma_f32_32x32x16_bf16 v[32:47], a[140:143], a[104:107], v[32:47]
ds_read_b64_tr_b16 a[128:129], v5 offset:9376
ds_read_b64_tr_b16 a[130:131], v5 offset:11680
v_exp_f32 v87, v31
v_add_f32 v8, v8, v86
v_cvt_pk_bf16_f32 v71, v86, v87
v_add_f32 v8, v8, v87
s_nop 0
v_permlane16_swap_b32 v67, v71
s_waitcnt lgkmcnt(10)
s_nop 0
v_mfma_f32_16x16x32_bf16 a[0:3], a[108:111], v[64:67], 0
s_add_u32 m0, s24, s20
s_add_u32 s19, s18, 4096
buffer_load_dwordx4 v6, s[64:67], s18 offen offset:0 sc1 lds
v_mfma_f32_16x16x32_bf16 a[36:39], a[108:111], v[68:71], 0
ds_read_b64_tr_b16 a[132:133], v5 offset:9408
ds_read_b64_tr_b16 a[134:135], v5 offset:11712
s_waitcnt lgkmcnt(10)
v_mfma_f32_16x16x32_bf16 a[4:7], a[112:115], v[64:67], 0
buffer_load_dwordx4 v6, s[64:67], s18 offen offset:1024 sc1 lds
v_mfma_f32_16x16x32_bf16 a[40:43], a[112:115], v[68:71], 0
ds_read_b64_tr_b16 a[136:137], v5 offset:9440
ds_read_b64_tr_b16 a[138:139], v5 offset:11744
s_waitcnt lgkmcnt(10)
v_mfma_f32_16x16x32_bf16 a[8:11], a[116:119], v[64:67], 0
buffer_load_dwordx4 v6, s[64:67], s18 offen offset:2048 sc1 lds
v_exp_f32 v80, v32
v_exp_f32 v81, v33
v_mfma_f32_16x16x32_bf16 a[44:47], a[116:119], v[68:71], 0
ds_read_b64_tr_b16 a[140:141], v5 offset:9472
ds_read_b64_tr_b16 a[142:143], v5 offset:11776
v_add_f32 v7, v8, v80
s_waitcnt lgkmcnt(10)
v_mfma_f32_16x16x32_bf16 a[12:15], a[120:123], v[64:67], 0
buffer_load_dwordx4 v6, s[64:67], s18 offen offset:3072 sc1 lds
v_cvt_pk_bf16_f32 v72, v80, v81
v_add_f32 v7, v7, v81
v_mfma_f32_16x16x32_bf16 a[48:51], a[120:123], v[68:71], 0
ds_read_b128 a[108:111], v4 offset:9216
v_exp_f32 v82, v40
s_waitcnt lgkmcnt(9)
v_mfma_f32_16x16x32_bf16 a[16:19], a[124:127], v[64:67], 0
s_add_u32 m0, m0, 4096
s_mov_b64 exec, 0xffffffff
buffer_load_dwordx4 v6, s[64:67], s19 offen sc1 lds
s_mov_b64 exec, -1
s_add_u32 s18, s18, 18432
s_add_u32 s20, s20, 18432
s_cmp_ge_u32 s20, 73728
s_cselect_b32 s20, 0, s20
v_exp_f32 v83, v41
v_add_f32 v7, v7, v82
v_mfma_f32_16x16x32_bf16 a[52:55], a[124:127], v[68:71], 0
ds_read_b128 a[112:115], v4 offset:9248
v_cvt_pk_bf16_f32 v76, v82, v83
s_waitcnt lgkmcnt(8)
v_mfma_f32_16x16x32_bf16 a[20:23], a[128:131], v[64:67], 0
v_add_f32 v7, v7, v83
v_exp_f32 v84, v34
v_mfma_f32_16x16x32_bf16 a[56:59], a[128:131], v[68:71], 0
ds_read_b128 a[116:119], v4 offset:9280
v_exp_f32 v85, v35
s_waitcnt lgkmcnt(7)
v_mfma_f32_16x16x32_bf16 a[24:27], a[132:135], v[64:67], 0
v_permlane16_swap_b32 v72, v76
v_add_f32 v7, v7, v84
v_mfma_f32_16x16x32_bf16 a[60:63], a[132:135], v[68:71], 0
ds_read_b128 a[120:123], v4 offset:9312
v_cvt_pk_bf16_f32 v73, v84, v85
s_waitcnt lgkmcnt(6)
v_mfma_f32_16x16x32_bf16 a[28:31], a[136:139], v[64:67], 0
v_add_f32 v7, v7, v85
v_exp_f32 v86, v42
v_mfma_f32_16x16x32_bf16 a[64:67], a[136:139], v[68:71], 0
ds_read_b128 a[124:127], v4 offset:9344
v_exp_f32 v87, v43
s_waitcnt lgkmcnt(5)
v_mfma_f32_16x16x32_bf16 a[32:35], a[140:143], v[64:67], 0
v_add_f32 v7, v7, v86
v_cvt_pk_bf16_f32 v77, v86, v87
v_mfma_f32_16x16x32_bf16 a[68:71], a[140:143], v[68:71], 0
ds_read_b128 a[128:131], v4 offset:9376
v_add_f32 v7, v7, v87
s_mov_b32 s23, 0
s_mov_b32 s21, 0
s_mov_b32 s22, 18432
K2_LOOP:
s_waitcnt vmcnt(5)
s_barrier
s_bitcmp1_b32 0x19, s23
s_cbranch_scc1 K2_C2X
K2_C2R:
s_setprio 3
s_waitcnt lgkmcnt(1)
v_mfma_f32_32x32x16_bf16 v[16:31], a[108:111], a[72:75], v[48:63]
ds_read_b128 a[132:135], v4 offset:9408
v_exp_f32 v80, v36
v_exp_f32 v81, v37
v_permlane16_swap_b32 v73, v77
s_add_u32 m0, s24, s20
s_add_u32 s19, s18, 4096
buffer_load_dwordx4 v6, s[64:67], s18 offen offset:0 sc1 lds
v_mfma_f32_32x32x16_bf16 v[16:31], a[112:115], a[76:79], v[16:31]
ds_read_b128 a[136:139], v4 offset:9440
v_add_f32 v7, v7, v80
v_cvt_pk_bf16_f32 v74, v80, v81
v_mfma_f32_32x32x16_bf16 v[16:31], a[116:119], a[80:83], v[16:31]
ds_read_b128 a[140:143], v4 offset:9472
v_add_f32 v7, v7, v81
v_exp_f32 v82, v44
v_exp_f32 v83, v45
buffer_load_dwordx4 v6, s[64:67], s18 offen offset:1024 sc1 lds
s_waitcnt lgkmcnt(1)
v_mfma_f32_32x32x16_bf16 v[16:31], a[120:123], a[84:87], v[16:31]
v_add_u32 v5, s21, v3
ds_read_b64_tr_b16 a[108:109], v5 offset:0
ds_read_b64_tr_b16 a[110:111], v5 offset:2304
v_add_f32 v7, v7, v82
v_cvt_pk_bf16_f32 v78, v82, v83
v_mfma_f32_32x32x16_bf16 v[16:31], a[124:127], a[88:91], v[16:31]
ds_read_b64_tr_b16 a[112:113], v5 offset:32
ds_read_b64_tr_b16 a[114:115], v5 offset:2336
v_add_f32 v7, v7, v83
v_exp_f32 v84, v38
v_exp_f32 v85, v39
buffer_load_dwordx4 v6, s[64:67], s18 offen offset:2048 sc1 lds
v_mfma_f32_32x32x16_bf16 v[16:31], a[128:131], a[92:95], v[16:31]
ds_read_b64_tr_b16 a[116:117], v5 offset:64
ds_read_b64_tr_b16 a[118:119], v5 offset:2368
v_permlane16_swap_b32 v74, v78
v_add_f32 v7, v7, v84
s_waitcnt lgkmcnt(4)
v_mfma_f32_32x32x16_bf16 v[16:31], a[132:135], a[96:99], v[16:31]
ds_read_b64_tr_b16 a[120:121], v5 offset:96
ds_read_b64_tr_b16 a[122:123], v5 offset:2400
v_cvt_pk_bf16_f32 v75, v84, v85
v_add_f32 v7, v7, v85
v_exp_f32 v86, v46
buffer_load_dwordx4 v6, s[64:67], s18 offen offset:3072 sc1 lds
v_mfma_f32_32x32x16_bf16 v[16:31], a[136:139], a[100:103], v[16:31]
ds_read_b64_tr_b16 a[124:125], v5 offset:128
ds_read_b64_tr_b16 a[126:127], v5 offset:2432
v_exp_f32 v87, v47
v_add_f32 v7, v7, v86
v_mfma_f32_32x32x16_bf16 v[16:31], a[140:143], a[104:107], v[16:31]
ds_read_b64_tr_b16 a[128:129], v5 offset:160
ds_read_b64_tr_b16 a[130:131], v5 offset:2464
v_cvt_pk_bf16_f32 v79, v86, v87
v_add_f32 v7, v7, v87
s_add_u32 m0, m0, 4096
s_mov_b64 exec, 0xffffffff
buffer_load_dwordx4 v6, s[64:67], s19 offen sc1 lds
s_mov_b64 exec, -1
s_add_u32 s18, s18, 18432
s_add_u32 s20, s20, 18432
s_cmp_ge_u32 s20, 73728
s_cselect_b32 s20, 0, s20
s_setprio 2
v_cmp_nle_f32 vcc, v7, v9
v_permlane16_swap_b32 v75, v79
s_cbranch_vccnz K2_RARE_A
K2_RARE_A_ret:
s_waitcnt lgkmcnt(6)
v_mfma_f32_16x16x32_bf16 a[0:3], a[108:111], v[72:75], a[0:3]
v_mfma_f32_16x16x32_bf16 a[36:39], a[108:111], v[76:79], a[36:39]
ds_read_b64_tr_b16 a[132:133], v5 offset:192
ds_read_b64_tr_b16 a[134:135], v5 offset:2496
v_mfma_f32_16x16x32_bf16 a[4:7], a[112:115], v[72:75], a[4:7]
v_mfma_f32_16x16x32_bf16 a[40:43], a[112:115], v[76:79], a[40:43]
ds_read_b64_tr_b16 a[136:137], v5 offset:224
ds_read_b64_tr_b16 a[138:139], v5 offset:2528
v_mfma_f32_16x16x32_bf16 a[8:11], a[116:119], v[72:75], a[8:11]
v_exp_f32 v80, v16
v_exp_f32 v81, v17
v_mfma_f32_16x16x32_bf16 a[44:47], a[116:119], v[76:79], a[44:47]
ds_read_b64_tr_b16 a[140:141], v5 offset:256
ds_read_b64_tr_b16 a[142:143], v5 offset:2560
v_add_f32 v8, v7, v80
s_waitcnt lgkmcnt(6)
v_mfma_f32_16x16x32_bf16 a[12:15], a[120:123], v[72:75], a[12:15]
v_cvt_pk_bf16_f32 v64, v80, v81
v_add_f32 v8, v8, v81
v_mfma_f32_16x16x32_bf16 a[48:51], a[120:123], v[76:79], a[48:51]
v_add_u32 v4, s22, v2
ds_read_b128 a[108:111], v4 offset:0
v_exp_f32 v82, v24
v_mfma_f32_16x16x32_bf16 a[16:19], a[124:127], v[72:75], a[16:19]
v_exp_f32 v83, v25
v_add_f32 v8, v8, v82
v_mfma_f32_16x16x32_bf16 a[52:55], a[124:127], v[76:79], a[52:55]
ds_read_b128 a[112:115], v4 offset:32
v_cvt_pk_bf16_f32 v68, v82, v83
v_mfma_f32_16x16x32_bf16 a[20:23], a[128:131], v[72:75], a[20:23]
v_add_f32 v8, v8, v83
v_exp_f32 v84, v18
v_mfma_f32_16x16x32_bf16 a[56:59], a[128:131], v[76:79], a[56:59]
ds_read_b128 a[116:119], v4 offset:64
v_exp_f32 v85, v19
s_waitcnt lgkmcnt(3)
v_mfma_f32_16x16x32_bf16 a[24:27], a[132:135], v[72:75], a[24:27]
v_permlane16_swap_b32 v64, v68
v_add_f32 v8, v8, v84
v_mfma_f32_16x16x32_bf16 a[60:63], a[132:135], v[76:79], a[60:63]
ds_read_b128 a[120:123], v4 offset:96
v_cvt_pk_bf16_f32 v65, v84, v85
v_mfma_f32_16x16x32_bf16 a[28:31], a[136:139], v[72:75], a[28:31]
v_add_f32 v8, v8, v85
v_exp_f32 v86, v26
v_mfma_f32_16x16x32_bf16 a[64:67], a[136:139], v[76:79], a[64:67]
ds_read_b128 a[124:127], v4 offset:128
v_exp_f32 v87, v27
v_mfma_f32_16x16x32_bf16 a[32:35], a[140:143], v[72:75], a[32:35]
v_add_f32 v8, v8, v86
v_cvt_pk_bf16_f32 v69, v86, v87
v_mfma_f32_16x16x32_bf16 a[68:71], a[140:143], v[76:79], a[68:71]
ds_read_b128 a[128:131], v4 offset:160
v_add_f32 v8, v8, v87
s_setprio 1
s_waitcnt lgkmcnt(1)
v_mfma_f32_32x32x16_bf16 v[32:47], a[108:111], a[72:75], v[48:63]
ds_read_b128 a[132:135], v4 offset:192
v_exp_f32 v80, v20
v_exp_f32 v81, v21
v_permlane16_swap_b32 v65, v69
v_mfma_f32_32x32x16_bf16 v[32:47], a[112:115], a[76:79], v[32:47]
ds_read_b128 a[136:139], v4 offset:224
v_add_f32 v8, v8, v80
v_cvt_pk_bf16_f32 v66, v80, v81
v_mfma_f32_32x32x16_bf16 v[32:47], a[116:119], a[80:83], v[32:47]
ds_read_b128 a[140:143], v4 offset:256
v_add_f32 v8, v8, v81
v_exp_f32 v82, v28
v_exp_f32 v83, v29
s_waitcnt lgkmcnt(1)
v_mfma_f32_32x32x16_bf16 v[32:47], a[120:123], a[84:87], v[32:47]
ds_read_b64_tr_b16 a[108:109], v5 offset:9216
ds_read_b64_tr_b16 a[110:111], v5 offset:11520
v_add_f32 v8, v8, v82
v_cvt_pk_bf16_f32 v70, v82, v83
v_mfma_f32_32x32x16_bf16 v[32:47], a[124:127], a[88:91], v[32:47]
ds_read_b64_tr_b16 a[112:113], v5 offset:9248
ds_read_b64_tr_b16 a[114:115], v5 offset:11552
v_add_f32 v8, v8, v83
v_exp_f32 v84, v22
v_exp_f32 v85, v23
v_mfma_f32_32x32x16_bf16 v[32:47], a[128:131], a[92:95], v[32:47]
ds_read_b64_tr_b16 a[116:117], v5 offset:9280
ds_read_b64_tr_b16 a[118:119], v5 offset:11584
v_permlane16_swap_b32 v66, v70
v_add_f32 v8, v8, v84
s_waitcnt lgkmcnt(4)
v_mfma_f32_32x32x16_bf16 v[32:47], a[132:135], a[96:99], v[32:47]
ds_read_b64_tr_b16 a[120:121], v5 offset:9312
ds_read_b64_tr_b16 a[122:123], v5 offset:11616
v_cvt_pk_bf16_f32 v67, v84, v85
v_add_f32 v8, v8, v85
v_exp_f32 v86, v30
v_mfma_f32_32x32x16_bf16 v[32:47], a[136:139], a[100:103], v[32:47]
ds_read_b64_tr_b16 a[124:125], v5 offset:9344
ds_read_b64_tr_b16 a[126:127], v5 offset:11648
v_exp_f32 v87, v31
v_add_f32 v8, v8, v86
v_mfma_f32_32x32x16_bf16 v[32:47], a[140:143], a[104:107], v[32:47]
ds_read_b64_tr_b16 a[128:129], v5 offset:9376
ds_read_b64_tr_b16 a[130:131], v5 offset:11680
v_cvt_pk_bf16_f32 v71, v86, v87
v_add_f32 v8, v8, v87
s_setprio 0
v_cmp_nle_f32 vcc, v8, v9
v_permlane16_swap_b32 v67, v71
s_cbranch_vccnz K2_RARE_B
K2_RARE_B_ret:
s_waitcnt lgkmcnt(6)
v_mfma_f32_16x16x32_bf16 a[0:3], a[108:111], v[64:67], a[0:3]
s_mov_b32 s21, s22
s_add_u32 s22, s22, 18432
v_mfma_f32_16x16x32_bf16 a[36:39], a[108:111], v[68:71], a[36:39]
ds_read_b64_tr_b16 a[132:133], v5 offset:9408
ds_read_b64_tr_b16 a[134:135], v5 offset:11712
s_cmp_ge_u32 s22, 73728
s_cselect_b32 s22, 0, s22
s_add_u32 s23, s23, 1
v_mfma_f32_16x16x32_bf16 a[4:7], a[112:115], v[64:67], a[4:7]
v_mfma_f32_16x16x32_bf16 a[40:43], a[112:115], v[68:71], a[40:43]
ds_read_b64_tr_b16 a[136:137], v5 offset:9440
ds_read_b64_tr_b16 a[138:139], v5 offset:11744
s_cmp_eq_u32 s23, 5
s_cselect_b32 s18, s32, s18
s_cmp_eq_u32 s23, 6
s_cselect_b32 s18, s33, s18
v_mfma_f32_16x16x32_bf16 a[8:11], a[116:119], v[64:67], a[8:11]
v_exp_f32 v80, v32
v_exp_f32 v81, v33
v_mfma_f32_16x16x32_bf16 a[44:47], a[116:119], v[68:71], a[44:47]
ds_read_b64_tr_b16 a[140:141], v5 offset:9472
ds_read_b64_tr_b16 a[142:143], v5 offset:11776
v_add_f32 v7, v8, v80
s_waitcnt lgkmcnt(6)
v_mfma_f32_16x16x32_bf16 a[12:15], a[120:123], v[64:67], a[12:15]
v_cvt_pk_bf16_f32 v72, v80, v81
v_add_f32 v7, v7, v81
v_mfma_f32_16x16x32_bf16 a[48:51], a[120:123], v[68:71], a[48:51]
ds_read_b128 a[108:111], v4 offset:9216
v_exp_f32 v82, v40
v_mfma_f32_16x16x32_bf16 a[16:19], a[124:127], v[64:67], a[16:19]
v_exp_f32 v83, v41
v_add_f32 v7, v7, v82
v_mfma_f32_16x16x32_bf16 a[52:55], a[124:127], v[68:71], a[52:55]
ds_read_b128 a[112:115], v4 offset:9248
v_cvt_pk_bf16_f32 v76, v82, v83
v_mfma_f32_16x16x32_bf16 a[20:23], a[128:131], v[64:67], a[20:23]
v_add_f32 v7, v7, v83
v_exp_f32 v84, v34
v_mfma_f32_16x16x32_bf16 a[56:59], a[128:131], v[68:71], a[56:59]
ds_read_b128 a[116:119], v4 offset:9280
v_exp_f32 v85, v35
s_waitcnt lgkmcnt(3)
v_mfma_f32_16x16x32_bf16 a[24:27], a[132:135], v[64:67], a[24:27]
v_permlane16_swap_b32 v72, v76
v_add_f32 v7, v7, v84
v_mfma_f32_16x16x32_bf16 a[60:63], a[132:135], v[68:71], a[60:63]
ds_read_b128 a[120:123], v4 offset:9312
v_cvt_pk_bf16_f32 v73, v84, v85
v_mfma_f32_16x16x32_bf16 a[28:31], a[136:139], v[64:67], a[28:31]
v_add_f32 v7, v7, v85
v_exp_f32 v86, v42
v_mfma_f32_16x16x32_bf16 a[64:67], a[136:139], v[68:71], a[64:67]
ds_read_b128 a[124:127], v4 offset:9344
v_exp_f32 v87, v43
v_mfma_f32_16x16x32_bf16 a[32:35], a[140:143], v[64:67], a[32:35]
v_add_f32 v7, v7, v86
v_cvt_pk_bf16_f32 v77, v86, v87
v_mfma_f32_16x16x32_bf16 a[68:71], a[140:143], v[68:71], a[68:71]
ds_read_b128 a[128:131], v4 offset:9376
v_add_f32 v7, v7, v87
s_cmp_lt_u32 s23, 7
s_cbranch_scc1 K2_LOOP
s_cmp_eq_u32 s14, 16
s_cbranch_scc0 K2_T15
s_waitcnt lgkmcnt(0)
v_add_u32 v5, s21, v3
ds_read_b64_tr_b16 a[108:109], v5 offset:0
ds_read_b64_tr_b16 a[110:111], v5 offset:2304
ds_read_b64_tr_b16 a[112:113], v5 offset:32
ds_read_b64_tr_b16 a[114:115], v5 offset:2336
ds_read_b64_tr_b16 a[116:117], v5 offset:64
ds_read_b64_tr_b16 a[118:119], v5 offset:2368
ds_read_b64_tr_b16 a[120:121], v5 offset:96
ds_read_b64_tr_b16 a[122:123], v5 offset:2400
ds_read_b64_tr_b16 a[124:125], v5 offset:128
ds_read_b64_tr_b16 a[126:127], v5 offset:2432
ds_read_b64_tr_b16 a[128:129], v5 offset:160
ds_read_b64_tr_b16 a[130:131], v5 offset:2464
ds_read_b64_tr_b16 a[132:133], v5 offset:192
ds_read_b64_tr_b16 a[134:135], v5 offset:2496
v_exp_f32 v80, v36
v_exp_f32 v81, v37
v_permlane16_swap_b32 v73, v77
v_add_f32 v7, v7, v80
v_cvt_pk_bf16_f32 v74, v80, v81
v_add_f32 v7, v7, v81
v_exp_f32 v82, v44
v_exp_f32 v83, v45
v_add_f32 v7, v7, v82
v_cvt_pk_bf16_f32 v78, v82, v83
v_add_f32 v7, v7, v83
v_exp_f32 v84, v38
v_exp_f32 v85, v39
v_permlane16_swap_b32 v74, v78
v_add_f32 v7, v7, v84
v_cvt_pk_bf16_f32 v75, v84, v85
v_add_f32 v7, v7, v85
v_exp_f32 v86, v46
v_exp_f32 v87, v47
v_add_f32 v7, v7, v86
v_cvt_pk_bf16_f32 v79, v86, v87
v_add_f32 v7, v7, v87
v_cmp_nle_f32 vcc, v7, v9
v_permlane16_swap_b32 v75, v79
s_cbranch_vccnz K2_RARE_T
K2_RARE_T_ret:
s_waitcnt lgkmcnt(12)
v_mfma_f32_16x16x32_bf16 a[0:3], a[108:111], v[72:75], a[0:3]
v_mfma_f32_16x16x32_bf16 a[36:39], a[108:111], v[76:79], a[36:39]
ds_read_b64_tr_b16 a[136:137], v5 offset:224
ds_read_b64_tr_b16 a[138:139], v5 offset:2528
s_waitcnt lgkmcnt(12)
v_mfma_f32_16x16x32_bf16 a[4:7], a[112:115], v[72:75], a[4:7]
v_mfma_f32_16x16x32_bf16 a[40:43], a[112:115], v[76:79], a[40:43]
ds_read_b64_tr_b16 a[140:141], v5 offset:256
ds_read_b64_tr_b16 a[142:143], v5 offset:2560
s_waitcnt lgkmcnt(12)
v_mfma_f32_16x16x32_bf16 a[8:11], a[116:119], v[72:75], a[8:11]
v_mfma_f32_16x16x32_bf16 a[44:47], a[116:119], v[76:79], a[44:47]
s_waitcnt lgkmcnt(10)
v_mfma_f32_16x16x32_bf16 a[12:15], a[120:123], v[72:75], a[12:15]
v_mfma_f32_16x16x32_bf16 a[48:51], a[120:123], v[76:79], a[48:51]
s_waitcnt lgkmcnt(8)
v_mfma_f32_16x16x32_bf16 a[16:19], a[124:127], v[72:75], a[16:19]
v_mfma_f32_16x16x32_bf16 a[52:55], a[124:127], v[76:79], a[52:55]
s_waitcnt lgkmcnt(6)
v_mfma_f32_16x16x32_bf16 a[20:23], a[128:131], v[72:75], a[20:23]
v_mfma_f32_16x16x32_bf16 a[56:59], a[128:131], v[76:79], a[56:59]
s_waitcnt lgkmcnt(4)
v_mfma_f32_16x16x32_bf16 a[24:27], a[132:135], v[72:75], a[24:27]
v_mfma_f32_16x16x32_bf16 a[60:63], a[132:135], v[76:79], a[60:63]
s_waitcnt lgkmcnt(2)
v_mfma_f32_16x16x32_bf16 a[28:31], a[136:139], v[72:75], a[28:31]
v_mfma_f32_16x16x32_bf16 a[64:67], a[136:139], v[76:79], a[64:67]
s_waitcnt lgkmcnt(0)
v_mfma_f32_16x16x32_bf16 a[32:35], a[140:143], v[72:75], a[32:35]
v_mfma_f32_16x16x32_bf16 a[68:71], a[140:143], v[76:79], a[68:71]
v_mov_b32 v8, v7
K2_T15:
s_setprio 0
s_mul_i32 s48, s34, 9216
s_lshl_b32 s49, s76, 10
s_add_u32 s50, s48, 14295040
s_add_u32 s49, s49, s48
s_add_u32 s49, s49, 14286848
buffer_load_dwordx4 v[96:99], v10, s[64:67], s49 offen sc1
buffer_load_dwordx4 v[100:103], v10, s[64:67], s50 offen sc1
v_and_b32 v4, 31, v1
v_mul_u32_u24 v4, 288, v4
v_lshrrev_b32 v5, 5, v1
v_lshl_add_u32 v4, v5, 4, v4
s_lshl_b32 s49, s76, 6
s_add_u32 s22, s48, s49
buffer_load_dwordx4 v[104:107], v4, s[68:71], s22 offen
buffer_load_dwordx4 v[108:111], v4, s[68:71], s22 offen offset:32
v_mov_b32 v89, v8
v_sub_f32 v88, 0, v48
s_nop 0
v_permlane32_swap_b32 v89, v8
v_add_f32 v89, v89, v8
s_add_u32 s25, s12, 4
s_mul_i32 s25, s25, 9216
s_sub_u32 s26, 73728, s30
s_add_u32 s26, s26, s25
s_add_u32 s25, s25, s30
v_add_u32 v91, s25, v10
v_add_u32 v12, s26, v10
v_lshrrev_b32 v93, 1, v10
s_lshl_b32 s25, s76, 9
s_xor_b32 s26, s25, 2048
s_add_u32 s25, s25, 159744
s_add_u32 s26, s26, 159744
v_add_u32 v90, s25, v93
v_add_u32 v87, s26, v93
ds_write_b64 v90, v[88:89]
v_and_b32 v90, 0x2f, v1
v_lshlrev_b32 v90, 4, v90
s_lshl_b32 s25, s13, 8
v_add_u32 v90, s25, v90
v_bfe_u32 v13, v1, 4, 1
v_lshl_add_u32 v92, v13, 3, v90
v_lshl_add_u32 v90, v13, 10, v90
s_lshl_b32 s27, s15, 2
s_add_u32 s27, s27, s16
s_mul_i32 s28, s27, 9216
s_add_u32 s28, s28, 4784128
s_add_u32 s26, s28, 4096
s_add_u32 s25, s28, 8192
s_lshl_b32 s27, s27, 8
s_add_u32 s27, s27, 14024704
s_waitcnt vmcnt(4) lgkmcnt(0)
s_barrier
s_cmp_eq_u32 s13, 0
s_cbranch_scc0 K2_EPI1
ds_read_b64 v[94:95], v87
ds_write_b128 v91, a[36:39] offset:0
ds_write_b128 v91, a[40:43] offset:1024
ds_write_b128 v91, a[44:47] offset:2048
ds_write_b128 v91, a[48:51] offset:3072
ds_write_b128 v91, a[52:55] offset:4096
ds_write_b128 v91, a[56:59] offset:5120
ds_write_b128 v91, a[60:63] offset:6144
ds_write_b128 v91, a[64:67] offset:7168
ds_write_b128 v91, a[68:71] offset:8192
s_waitcnt lgkmcnt(9)
v_max_f32 v80, v88, v94
v_sub_f32 v82, v88, v80
v_sub_f32 v84, v94, v80
v_exp_f32 v82, v82
v_exp_f32 v84, v84
v_mul_f32 v81, v89, v82
v_fmac_f32 v81, v95, v84
v_rcp_f32 v86, v81
s_nop 0
v_mul_f32 v82, v82, v86
v_mul_f32 v84, v84, v86
v_mov_b32 v83, v82
v_mov_b32 v85, v84
s_nop 0
v_permlane16_swap_b32 v82, v83
v_permlane16_swap_b32 v84, v85
s_waitcnt vmcnt(0) lgkmcnt(0)
s_barrier
ds_read_b128 v[16:19], v12 offset:0
ds_read_b128 v[20:23], v12 offset:1024
ds_read_b128 v[24:27], v12 offset:2048
ds_read_b128 v[28:31], v12 offset:3072
ds_read_b128 v[32:35], v12 offset:4096
ds_read_b128 v[36:39], v12 offset:5120
ds_read_b128 v[40:43], v12 offset:6144
ds_read_b128 v[44:47], v12 offset:7168
ds_read_b128 v[48:51], v12 offset:8192
s_cmp_eq_u32 s12, s16
s_cbranch_scc1 K2_SKM
s_mov_b64 exec, 0xffffffff
buffer_store_dwordx2 v[80:81], v93, s[64:67], s27 offen sc1
s_mov_b64 exec, -1
K2_SKM:
v_accvgpr_read_b32 v52, a0
v_accvgpr_read_b32 v53, a1
v_accvgpr_read_b32 v54, a2
v_accvgpr_read_b32 v55, a3
v_accvgpr_read_b32 v56, a4
v_accvgpr_read_b32 v57, a5
v_accvgpr_read_b32 v58, a6
v_accvgpr_read_b32 v59, a7
v_pk_mul_f32 v[52:53], v[52:53], v[82:83] op_sel:[0,0] op_sel_hi:[1,0]
v_pk_mul_f32 v[54:55], v[54:55], v[82:83] op_sel:[0,0] op_sel_hi:[1,0]
v_pk_mul_f32 v[56:57], v[56:57], v[82:83] op_sel:[0,0] op_sel_hi:[1,0]
v_pk_mul_f32 v[58:59], v[58:59], v[82:83] op_sel:[0,0] op_sel_hi:[1,0]
s_waitcnt lgkmcnt(7)
v_pk_fma_f32 v[52:53], v[16:17], v[84:85], v[52:53] op_sel:[0,0,0] op_sel_hi:[1,0,1]
v_pk_fma_f32 v[54:55], v[18:19], v[84:85], v[54:55] op_sel:[0,0,0] op_sel_hi:[1,0,1]
v_pk_fma_f32 v[56:57], v[20:21], v[84:85], v[56:57] op_sel:[0,0,0] op_sel_hi:[1,0,1]
v_pk_fma_f32 v[58:59], v[22:23], v[84:85], v[58:59] op_sel:[0,0,0] op_sel_hi:[1,0,1]
v_cvt_pk_bf16_f32 v64, v52, v53
v_cvt_pk_bf16_f32 v65, v54, v55
v_cvt_pk_bf16_f32 v66, v56, v57
v_cvt_pk_bf16_f32 v67, v58, v59
s_nop 0
v_permlane16_swap_b32 v64, v66
v_permlane16_swap_b32 v65, v67
s_cbranch_scc1 K2_SK00
buffer_store_dwordx4 v[64:67], v90, s[64:67], s28 offen offset:0 sc1
K2_SK00:
v_accvgpr_read_b32 v52, a8
v_accvgpr_read_b32 v53, a9
v_accvgpr_read_b32 v54, a10
v_accvgpr_read_b32 v55, a11
v_accvgpr_read_b32 v56, a12
v_accvgpr_read_b32 v57, a13
v_accvgpr_read_b32 v58, a14
v_accvgpr_read_b32 v59, a15
v_pk_mul_f32 v[52:53], v[52:53], v[82:83] op_sel:[0,0] op_sel_hi:[1,0]
v_pk_mul_f32 v[54:55], v[54:55], v[82:83] op_sel:[0,0] op_sel_hi:[1,0]
v_pk_mul_f32 v[56:57], v[56:57], v[82:83] op_sel:[0,0] op_sel_hi:[1,0]
v_pk_mul_f32 v[58:59], v[58:59], v[82:83] op_sel:[0,0] op_sel_hi:[1,0]
s_waitcnt lgkmcnt(5)
v_pk_fma_f32 v[52:53], v[24:25], v[84:85], v[52:53] op_sel:[0,0,0] op_sel_hi:[1,0,1]
v_pk_fma_f32 v[54:55], v[26:27], v[84:85], v[54:55] op_sel:[0,0,0] op_sel_hi:[1,0,1]
v_pk_fma_f32 v[56:57], v[28:29], v[84:85], v[56:57] op_sel:[0,0,0] op_sel_hi:[1,0,1]
v_pk_fma_f32 v[58:59], v[30:31], v[84:85], v[58:59] op_sel:[0,0,0] op_sel_hi:[1,0,1]
v_cvt_pk_bf16_f32 v68, v52, v53
v_cvt_pk_bf16_f32 v69, v54, v55
v_cvt_pk_bf16_f32 v70, v56, v57
v_cvt_pk_bf16_f32 v71, v58, v59
s_nop 0
v_permlane16_swap_b32 v68, v70
v_permlane16_swap_b32 v69, v71
s_cbranch_scc1 K2_SK01
buffer_store_dwordx4 v[68:71], v90, s[64:67], s28 offen offset:2048 sc1
K2_SK01:
v_accvgpr_read_b32 v52, a16
v_accvgpr_read_b32 v53, a17
v_accvgpr_read_b32 v54, a18
v_accvgpr_read_b32 v55, a19
v_accvgpr_read_b32 v56, a20
v_accvgpr_read_b32 v57, a21
v_accvgpr_read_b32 v58, a22
v_accvgpr_read_b32 v59, a23
v_pk_mul_f32 v[52:53], v[52:53], v[82:83] op_sel:[0,0] op_sel_hi:[1,0]
v_pk_mul_f32 v[54:55], v[54:55], v[82:83] op_sel:[0,0] op_sel_hi:[1,0]
v_pk_mul_f32 v[56:57], v[56:57], v[82:83] op_sel:[0,0] op_sel_hi:[1,0]
v_pk_mul_f32 v[58:59], v[58:59], v[82:83] op_sel:[0,0] op_sel_hi:[1,0]
s_waitcnt lgkmcnt(3)
v_pk_fma_f32 v[52:53], v[32:33], v[84:85], v[52:53] op_sel:[0,0,0] op_sel_hi:[1,0,1]
v_pk_fma_f32 v[54:55], v[34:35], v[84:85], v[54:55] op_sel:[0,0,0] op_sel_hi:[1,0,1]
v_pk_fma_f32 v[56:57], v[36:37], v[84:85], v[56:57] op_sel:[0,0,0] op_sel_hi:[1,0,1]
v_pk_fma_f32 v[58:59], v[38:39], v[84:85], v[58:59] op_sel:[0,0,0] op_sel_hi:[1,0,1]
v_cvt_pk_bf16_f32 v72, v52, v53
v_cvt_pk_bf16_f32 v73, v54, v55
v_cvt_pk_bf16_f32 v74, v56, v57
v_cvt_pk_bf16_f32 v75, v58, v59
s_nop 0
v_permlane16_swap_b32 v72, v74
v_permlane16_swap_b32 v73, v75
s_cbranch_scc1 K2_SK02
buffer_store_dwordx4 v[72:75], v90, s[64:67], s26 offen offset:0 sc1
K2_SK02:
v_accvgpr_read_b32 v52, a24
v_accvgpr_read_b32 v53, a25
v_accvgpr_read_b32 v54, a26
v_accvgpr_read_b32 v55, a27
v_accvgpr_read_b32 v56, a28
v_accvgpr_read_b32 v57, a29
v_accvgpr_read_b32 v58, a30
v_accvgpr_read_b32 v59, a31
v_pk_mul_f32 v[52:53], v[52:53], v[82:83] op_sel:[0,0] op_sel_hi:[1,0]
v_pk_mul_f32 v[54:55], v[54:55], v[82:83] op_sel:[0,0] op_sel_hi:[1,0]
v_pk_mul_f32 v[56:57], v[56:57], v[82:83] op_sel:[0,0] op_sel_hi:[1,0]
v_pk_mul_f32 v[58:59], v[58:59], v[82:83] op_sel:[0,0] op_sel_hi:[1,0]
s_waitcnt lgkmcnt(1)
v_pk_fma_f32 v[52:53], v[40:41], v[84:85], v[52:53] op_sel:[0,0,0] op_sel_hi:[1,0,1]
v_pk_fma_f32 v[54:55], v[42:43], v[84:85], v[54:55] op_sel:[0,0,0] op_sel_hi:[1,0,1]
v_pk_fma_f32 v[56:57], v[44:45], v[84:85], v[56:57] op_sel:[0,0,0] op_sel_hi:[1,0,1]
v_pk_fma_f32 v[58:59], v[46:47], v[84:85], v[58:59] op_sel:[0,0,0] op_sel_hi:[1,0,1]
v_cvt_pk_bf16_f32 v76, v52, v53
v_cvt_pk_bf16_f32 v77, v54, v55
v_cvt_pk_bf16_f32 v78, v56, v57
v_cvt_pk_bf16_f32 v79, v58, v59
s_nop 0
v_permlane16_swap_b32 v76, v78
v_permlane16_swap_b32 v77, v79
s_cbranch_scc1 K2_SK03
buffer_store_dwordx4 v[76:79], v90, s[64:67], s26 offen offset:2048 sc1
K2_SK03:
v_accvgpr_read_b32 v52, a32
v_accvgpr_read_b32 v53, a33
v_accvgpr_read_b32 v54, a34
v_accvgpr_read_b32 v55, a35
v_pk_mul_f32 v[52:53], v[52:53], v[82:83] op_sel:[0,0] op_sel_hi:[1,0]
v_pk_mul_f32 v[54:55], v[54:55], v[82:83] op_sel:[0,0] op_sel_hi:[1,0]
s_waitcnt lgkmcnt(0)
v_pk_fma_f32 v[52:53], v[48:49], v[84:85], v[52:53] op_sel:[0,0,0] op_sel_hi:[1,0,1]
v_pk_fma_f32 v[54:55], v[50:51], v[84:85], v[54:55] op_sel:[0,0,0] op_sel_hi:[1,0,1]
v_cvt_pk_bf16_f32 v60, v52, v53
v_cvt_pk_bf16_f32 v61, v54, v55
s_cbranch_scc1 K2_SK04
buffer_store_dwordx2 v[60:61], v92, s[64:67], s25 offen sc1
K2_SK04:
s_branch K2_E2
K2_EPI1:
ds_read_b64 v[94:95], v87
ds_write_b128 v91, a[0:3] offset:0
ds_write_b128 v91, a[4:7] offset:1024
ds_write_b128 v91, a[8:11] offset:2048
ds_write_b128 v91, a[12:15] offset:3072
ds_write_b128 v91, a[16:19] offset:4096
ds_write_b128 v91, a[20:23] offset:5120
ds_write_b128 v91, a[24:27] offset:6144
ds_write_b128 v91, a[28:31] offset:7168
ds_write_b128 v91, a[32:35] offset:8192
s_waitcnt lgkmcnt(9)
v_max_f32 v80, v88, v94
v_sub_f32 v82, v88, v80
v_sub_f32 v84, v94, v80
v_exp_f32 v82, v82
v_exp_f32 v84, v84
v_mul_f32 v81, v89, v82
v_fmac_f32 v81, v95, v84
v_rcp_f32 v86, v81
s_nop 0
v_mul_f32 v82, v82, v86
v_mul_f32 v84, v84, v86
v_mov_b32 v83, v82
v_mov_b32 v85, v84
s_nop 0
v_permlane16_swap_b32 v82, v83
v_permlane16_swap_b32 v84, v85
s_waitcnt vmcnt(0) lgkmcnt(0)
s_barrier
ds_read_b128 v[16:19], v12 offset:0
ds_read_b128 v[20:23], v12 offset:1024
ds_read_b128 v[24:27], v12 offset:2048
ds_read_b128 v[28:31], v12 offset:3072
ds_read_b128 v[32:35], v12 offset:4096
ds_read_b128 v[36:39], v12 offset:5120
ds_read_b128 v[40:43], v12 offset:6144
ds_read_b128 v[44:47], v12 offset:7168
ds_read_b128 v[48:51], v12 offset:8192
s_cmp_eq_u32 s12, s16
v_accvgpr_read_b32 v52, a36
v_accvgpr_read_b32 v53, a37
v_accvgpr_read_b32 v54, a38
v_accvgpr_read_b32 v55, a39
v_accvgpr_read_b32 v56, a40
v_accvgpr_read_b32 v57, a41
v_accvgpr_read_b32 v58, a42
v_accvgpr_read_b32 v59, a43
v_pk_mul_f32 v[52:53], v[52:53], v[82:83] op_sel:[0,1] op_sel_hi:[1,1]
v_pk_mul_f32 v[54:55], v[54:55], v[82:83] op_sel:[0,1] op_sel_hi:[1,1]
v_pk_mul_f32 v[56:57], v[56:57], v[82:83] op_sel:[0,1] op_sel_hi:[1,1]
v_pk_mul_f32 v[58:59], v[58:59], v[82:83] op_sel:[0,1] op_sel_hi:[1,1]
s_waitcnt lgkmcnt(7)
v_pk_fma_f32 v[52:53], v[16:17], v[84:85], v[52:53] op_sel:[0,1,0] op_sel_hi:[1,1,1]
v_pk_fma_f32 v[54:55], v[18:19], v[84:85], v[54:55] op_sel:[0,1,0] op_sel_hi:[1,1,1]
v_pk_fma_f32 v[56:57], v[20:21], v[84:85], v[56:57] op_sel:[0,1,0] op_sel_hi:[1,1,1]
v_pk_fma_f32 v[58:59], v[22:23], v[84:85], v[58:59] op_sel:[0,1,0] op_sel_hi:[1,1,1]
v_cvt_pk_bf16_f32 v64, v52, v53
v_cvt_pk_bf16_f32 v65, v54, v55
v_cvt_pk_bf16_f32 v66, v56, v57
v_cvt_pk_bf16_f32 v67, v58, v59
s_nop 0
v_permlane16_swap_b32 v64, v66
v_permlane16_swap_b32 v65, v67
s_cbranch_scc1 K2_SK10
buffer_store_dwordx4 v[64:67], v90, s[64:67], s28 offen offset:0 sc1
K2_SK10:
v_accvgpr_read_b32 v52, a44
v_accvgpr_read_b32 v53, a45
v_accvgpr_read_b32 v54, a46
v_accvgpr_read_b32 v55, a47
v_accvgpr_read_b32 v56, a48
v_accvgpr_read_b32 v57, a49
v_accvgpr_read_b32 v58, a50
v_accvgpr_read_b32 v59, a51
v_pk_mul_f32 v[52:53], v[52:53], v[82:83] op_sel:[0,1] op_sel_hi:[1,1]
v_pk_mul_f32 v[54:55], v[54:55], v[82:83] op_sel:[0,1] op_sel_hi:[1,1]
v_pk_mul_f32 v[56:57], v[56:57], v[82:83] op_sel:[0,1] op_sel_hi:[1,1]
v_pk_mul_f32 v[58:59], v[58:59], v[82:83] op_sel:[0,1] op_sel_hi:[1,1]
s_waitcnt lgkmcnt(5)
v_pk_fma_f32 v[52:53], v[24:25], v[84:85], v[52:53] op_sel:[0,1,0] op_sel_hi:[1,1,1]
v_pk_fma_f32 v[54:55], v[26:27], v[84:85], v[54:55] op_sel:[0,1,0] op_sel_hi:[1,1,1]
v_pk_fma_f32 v[56:57], v[28:29], v[84:85], v[56:57] op_sel:[0,1,0] op_sel_hi:[1,1,1]
v_pk_fma_f32 v[58:59], v[30:31], v[84:85], v[58:59] op_sel:[0,1,0] op_sel_hi:[1,1,1]
v_cvt_pk_bf16_f32 v68, v52, v53
v_cvt_pk_bf16_f32 v69, v54, v55
v_cvt_pk_bf16_f32 v70, v56, v57
v_cvt_pk_bf16_f32 v71, v58, v59
s_nop 0
v_permlane16_swap_b32 v68, v70
v_permlane16_swap_b32 v69, v71
s_cbranch_scc1 K2_SK11
buffer_store_dwordx4 v[68:71], v90, s[64:67], s28 offen offset:2048 sc1
K2_SK11:
v_accvgpr_read_b32 v52, a52
v_accvgpr_read_b32 v53, a53
v_accvgpr_read_b32 v54, a54
v_accvgpr_read_b32 v55, a55
v_accvgpr_read_b32 v56, a56
v_accvgpr_read_b32 v57, a57
v_accvgpr_read_b32 v58, a58
v_accvgpr_read_b32 v59, a59
v_pk_mul_f32 v[52:53], v[52:53], v[82:83] op_sel:[0,1] op_sel_hi:[1,1]
v_pk_mul_f32 v[54:55], v[54:55], v[82:83] op_sel:[0,1] op_sel_hi:[1,1]
v_pk_mul_f32 v[56:57], v[56:57], v[82:83] op_sel:[0,1] op_sel_hi:[1,1]
v_pk_mul_f32 v[58:59], v[58:59], v[82:83] op_sel:[0,1] op_sel_hi:[1,1]
s_waitcnt lgkmcnt(3)
v_pk_fma_f32 v[52:53], v[32:33], v[84:85], v[52:53] op_sel:[0,1,0] op_sel_hi:[1,1,1]
v_pk_fma_f32 v[54:55], v[34:35], v[84:85], v[54:55] op_sel:[0,1,0] op_sel_hi:[1,1,1]
v_pk_fma_f32 v[56:57], v[36:37], v[84:85], v[56:57] op_sel:[0,1,0] op_sel_hi:[1,1,1]
v_pk_fma_f32 v[58:59], v[38:39], v[84:85], v[58:59] op_sel:[0,1,0] op_sel_hi:[1,1,1]
v_cvt_pk_bf16_f32 v72, v52, v53
v_cvt_pk_bf16_f32 v73, v54, v55
v_cvt_pk_bf16_f32 v74, v56, v57
v_cvt_pk_bf16_f32 v75, v58, v59
s_nop 0
v_permlane16_swap_b32 v72, v74
v_permlane16_swap_b32 v73, v75
s_cbranch_scc1 K2_SK12
buffer_store_dwordx4 v[72:75], v90, s[64:67], s26 offen offset:0 sc1
K2_SK12:
v_accvgpr_read_b32 v52, a60
v_accvgpr_read_b32 v53, a61
v_accvgpr_read_b32 v54, a62
v_accvgpr_read_b32 v55, a63
v_accvgpr_read_b32 v56, a64
v_accvgpr_read_b32 v57, a65
v_accvgpr_read_b32 v58, a66
v_accvgpr_read_b32 v59, a67
v_pk_mul_f32 v[52:53], v[52:53], v[82:83] op_sel:[0,1] op_sel_hi:[1,1]
v_pk_mul_f32 v[54:55], v[54:55], v[82:83] op_sel:[0,1] op_sel_hi:[1,1]
v_pk_mul_f32 v[56:57], v[56:57], v[82:83] op_sel:[0,1] op_sel_hi:[1,1]
v_pk_mul_f32 v[58:59], v[58:59], v[82:83] op_sel:[0,1] op_sel_hi:[1,1]
s_waitcnt lgkmcnt(1)
v_pk_fma_f32 v[52:53], v[40:41], v[84:85], v[52:53] op_sel:[0,1,0] op_sel_hi:[1,1,1]
v_pk_fma_f32 v[54:55], v[42:43], v[84:85], v[54:55] op_sel:[0,1,0] op_sel_hi:[1,1,1]
v_pk_fma_f32 v[56:57], v[44:45], v[84:85], v[56:57] op_sel:[0,1,0] op_sel_hi:[1,1,1]
v_pk_fma_f32 v[58:59], v[46:47], v[84:85], v[58:59] op_sel:[0,1,0] op_sel_hi:[1,1,1]
v_cvt_pk_bf16_f32 v76, v52, v53
v_cvt_pk_bf16_f32 v77, v54, v55
v_cvt_pk_bf16_f32 v78, v56, v57
v_cvt_pk_bf16_f32 v79, v58, v59
s_nop 0
v_permlane16_swap_b32 v76, v78
v_permlane16_swap_b32 v77, v79
s_cbranch_scc1 K2_SK13
buffer_store_dwordx4 v[76:79], v90, s[64:67], s26 offen offset:2048 sc1
K2_SK13:
v_accvgpr_read_b32 v52, a68
v_accvgpr_read_b32 v53, a69
v_accvgpr_read_b32 v54, a70
v_accvgpr_read_b32 v55, a71
v_pk_mul_f32 v[52:53], v[52:53], v[82:83] op_sel:[0,1] op_sel_hi:[1,1]
v_pk_mul_f32 v[54:55], v[54:55], v[82:83] op_sel:[0,1] op_sel_hi:[1,1]
s_waitcnt lgkmcnt(0)
v_pk_fma_f32 v[52:53], v[48:49], v[84:85], v[52:53] op_sel:[0,1,0] op_sel_hi:[1,1,1]
v_pk_fma_f32 v[54:55], v[50:51], v[84:85], v[54:55] op_sel:[0,1,0] op_sel_hi:[1,1,1]
v_cvt_pk_bf16_f32 v60, v52, v53
v_cvt_pk_bf16_f32 v61, v54, v55
s_cbranch_scc1 K2_SK14
buffer_store_dwordx2 v[60:61], v92, s[64:67], s25 offen sc1
K2_SK14:
K2_E2:
s_cbranch_scc0 K2_E2W
v_sub_u32 v12, v12, v10
v_add_u32 v90, v12, v90
v_add_u32 v92, v12, v92
ds_write_b128 v90, v[64:67] offset:0
ds_write_b128 v90, v[68:71] offset:2048
ds_write_b128 v90, v[72:75] offset:4096
ds_write_b128 v90, v[76:79] offset:6144
ds_write_b64 v92, v[60:61] offset:8192
v_add_u32 v93, 156672, v93
ds_write_b64 v93, v[80:81]
K2_E2W:
s_cmp_eq_u32 s35, 0
s_cbranch_scc0 K2_OVALID
s_cmp_eq_u32 s55, 0
s_cbranch_scc1 K2_NOSIGB
v_lshrrev_b32 v86, 2, v10
v_mov_b32 v87, s77
s_waitcnt vmcnt(0)
s_mov_b64 exec, 0xffffffff
buffer_store_dword v87, v86, s[64:67], s55 offen sc1
s_mov_b64 exec, -1
s_mov_b32 s55, 0
K2_NOSIGB:
s_branch K2_END2
K2_OVALID:
v_lshrrev_b32 v82, 2, v1
v_and_b32 v83, 3, v1
s_lshl_b32 s25, s76, 8
s_add_u32 s26, s25, 73728
s_mov_b32 s27, 2304
v_lshlrev_b32 v84, 4, v82
v_add_u32 v84, s26, v84
v_add_u32 v85, 0, v83
v_and_b32 v86, 1, v85
v_lshrrev_b32 v85, 1, v85
v_lshl_add_u32 v86, v86, 3, v84
v_mad_u32_u24 v2, v85, s27, v86
v_add_u32 v85, 1, v83
v_and_b32 v86, 1, v85
v_lshrrev_b32 v85, 1, v85
v_lshl_add_u32 v86, v86, 3, v84
v_mad_u32_u24 v3, v85, s27, v86
v_sub_u32 v85, 3, v83
v_and_b32 v11, 1, v85
v_lshlrev_b32 v11, 4, v11
v_lshrrev_b32 v85, 1, v85
v_mul_u32_u24 v86, 80, v82
v_lshl_add_u32 v86, v85, 2, v86
s_mul_i32 s28, s76, 1280
s_add_u32 s28, s28, 96768
v_add_u32 v9, s28, v86
v_and_b32 v85, 1, v1
v_lshlrev_b32 v85, 3, v85
v_xor_b32 v85, v85, v82
v_lshlrev_b32 v85, 2, v85
v_mad_u32_u24 v85, v83, s27, v85
v_add_u32 v12, s26, v85
v_bfe_u32 v85, v1, 2, 1
v_lshrrev_b32 v86, 5, v1
v_xor_b32 v85, v85, v86
v_lshlrev_b32 v85, 5, v85
v_lshl_add_u32 v85, v83, 6, v85
v_bfe_u32 v86, v1, 2, 3
v_mad_u32_u24 v85, v86, s27, v85
v_add_u32 v13, s26, v85
s_lshl_b32 s25, s76, 10
s_add_u32 s25, s25, 147456
v_add_u32 v82, s25, v10
s_mov_b32 s23, 0
K2_CONV:
s_waitcnt lgkmcnt(0)
ds_read2_b32 v[40:41], v9 offset0:0 offset1:1
ds_read2_b32 v[42:43], v9 offset0:2 offset1:3
ds_read2_b32 v[44:45], v9 offset0:4 offset1:5
ds_read2_b32 v[46:47], v9 offset0:6 offset1:7
ds_read2_b32 v[48:49], v9 offset0:8 offset1:9
ds_read2_b32 v[50:51], v9 offset0:10 offset1:11
ds_read2_b32 v[52:53], v9 offset0:12 offset1:13
ds_read2_b32 v[54:55], v9 offset0:14 offset1:15
ds_read2_b32 v[56:57], v9 offset0:16 offset1:17
ds_read_b32 v58, v9 offset:72
ds_read_b64 v[14:15], v2 offset:0
ds_read_b64 v[22:23], v2 offset:4608
ds_read_b64 v[16:17], v3 offset:0
ds_read_b64 v[24:25], v3 offset:4608
ds_read_b64 v[18:19], v2 offset:2304
s_waitcnt lgkmcnt(5)
ds_read_b64 v[26:27], v2 offset:6912
ds_read_b64 v[20:21], v3 offset:2304
ds_read_b64 v[28:29], v3 offset:6912
ds_read_b64 v[30:31], v2 offset:9216
ds_read_b64 v[32:33], v3 offset:9216
ds_read_b64 v[34:35], v2 offset:11520
ds_read_b64 v[36:37], v3 offset:11520
ds_read_b64 v[38:39], v2 offset:13824
v_alignbit_b32 v40, v41, v40, v11
v_alignbit_b32 v41, v42, v41, v11
v_alignbit_b32 v42, v43, v42, v11
v_alignbit_b32 v43, v44, v43, v11
v_alignbit_b32 v44, v45, v44, v11
v_alignbit_b32 v45, v46, v45, v11
v_alignbit_b32 v46, v47, v46, v11
v_alignbit_b32 v47, v48, v47, v11
v_alignbit_b32 v48, v49, v48, v11
v_alignbit_b32 v49, v50, v49, v11
v_alignbit_b32 v50, v51, v50, v11
v_alignbit_b32 v51, v52, v51, v11
v_alignbit_b32 v52, v53, v52, v11
v_alignbit_b32 v53, v54, v53, v11
v_alignbit_b32 v54, v55, v54, v11
v_alignbit_b32 v55, v56, v55, v11
v_alignbit_b32 v56, v57, v56, v11
v_alignbit_b32 v57, v58, v57, v11
s_cmp_eq_u32 s55, 0
s_cbranch_scc1 K2_NOSIGA
v_lshrrev_b32 v86, 2, v10
v_mov_b32 v87, s77
s_waitcnt vmcnt(0)
s_mov_b64 exec, 0xffffffff
buffer_store_dword v87, v86, s[64:67], s55 offen sc1
s_mov_b64 exec, -1
s_mov_b32 s55, 0
K2_NOSIGA:
s_waitcnt lgkmcnt(0)
v_mfma_f32_4x4x4_16b_bf16 a[0:3], v[40:41], v[14:15], 0
v_mfma_f32_4x4x4_16b_bf16 a[4:7], v[40:41], v[22:23], 0
s_nop 0
v_mfma_f32_4x4x4_16b_bf16 a[0:3], v[42:43], v[16:17], a[0:3]
v_mfma_f32_4x4x4_16b_bf16 a[4:7], v[42:43], v[24:25], a[4:7]
s_nop 0
v_mfma_f32_4x4x4_16b_bf16 a[0:3], v[44:45], v[18:19], a[0:3]
v_mfma_f32_4x4x4_16b_bf16 a[4:7], v[44:45], v[26:27], a[4:7]
s_nop 0
v_mfma_f32_4x4x4_16b_bf16 a[0:3], v[46:47], v[20:21], a[0:3]
v_mfma_f32_4x4x4_16b_bf16 a[4:7], v[46:47], v[28:29], a[4:7]
s_nop 0
v_mfma_f32_4x4x4_16b_bf16 a[0:3], v[48:49], v[22:23], a[0:3]
v_mfma_f32_4x4x4_16b_bf16 a[4:7], v[48:49], v[30:31], a[4:7]
s_nop 0
v_mfma_f32_4x4x4_16b_bf16 a[0:3], v[50:51], v[24:25], a[0:3]
v_mfma_f32_4x4x4_16b_bf16 a[4:7], v[50:51], v[32:33], a[4:7]
s_nop 0
v_mfma_f32_4x4x4_16b_bf16 a[0:3], v[52:53], v[26:27], a[0:3]
v_mfma_f32_4x4x4_16b_bf16 a[4:7], v[52:53], v[34:35], a[4:7]
s_nop 0
v_mfma_f32_4x4x4_16b_bf16 a[0:3], v[54:55], v[28:29], a[0:3]
v_mfma_f32_4x4x4_16b_bf16 a[4:7], v[54:55], v[36:37], a[4:7]
s_nop 0
v_mfma_f32_4x4x4_16b_bf16 a[0:3], v[56:57], v[30:31], a[0:3]
v_mfma_f32_4x4x4_16b_bf16 a[4:7], v[56:57], v[38:39], a[4:7]
v_lshlrev_b32 v40, 16, v96
v_and_b32 v41, 0xffff0000, v96
v_lshlrev_b32 v42, 16, v97
v_and_b32 v43, 0xffff0000, v97
v_lshlrev_b32 v44, 16, v98
v_and_b32 v45, 0xffff0000, v98
v_lshlrev_b32 v46, 16, v99
v_and_b32 v47, 0xffff0000, v99
ds_write_b32 v12, a0 offset:0
ds_write_b32 v12, a1 offset:64
ds_write_b32 v12, a2 offset:128
ds_write_b32 v12, a3 offset:192
ds_write_b32 v12, a4 offset:9216
ds_write_b32 v12, a5 offset:9280
ds_write_b32 v12, a6 offset:9344
ds_write_b32 v12, a7 offset:9408
s_waitcnt lgkmcnt(0)
ds_read_b128 v[48:51], v13
ds_read_b128 v[52:55], v13 offset:16
s_waitcnt lgkmcnt(0)
v_pk_mul_f32 v[40:41], v[40:41], v[48:49]
v_pk_mul_f32 v[42:43], v[42:43], v[50:51]
v_pk_mul_f32 v[44:45], v[44:45], v[52:53]
v_pk_mul_f32 v[46:47], v[46:47], v[54:55]
v_cvt_pk_bf16_f32 v56, v40, v41
v_cvt_pk_bf16_f32 v57, v42, v43
v_cvt_pk_bf16_f32 v58, v44, v45
v_cvt_pk_bf16_f32 v59, v46, v47
ds_write_b128 v82, v[56:59]
s_add_u32 s23, s23, s76
s_cmp_eq_u32 s23, 1
s_cbranch_scc0 K2_CONV_E
v_add_u32 v2, 1792, v2
v_add_u32 v3, 1792, v3
v_add_u32 v12, 1792, v12
v_add_u32 v13, 1792, v13
v_add_u32 v82, 7168, v82
v_add_u32 v9, 8960, v9
v_mov_b32 v96, v100
v_mov_b32 v97, v101
v_mov_b32 v98, v102
v_mov_b32 v99, v103
s_branch K2_CONV
K2_CONV_E:
s_cmp_eq_u32 s6, 0
s_cbranch_scc1 K2_NOWFA
s_mov_b32 m0, s6
s_nop 0
buffer_load_dwordx4 v10, s[64:67], s7 offen offset:0 sc1 lds
buffer_load_dwordx4 v10, s[64:67], s7 offen offset:1024 sc1 lds
buffer_load_dwordx4 v10, s[64:67], s7 offen offset:2048 sc1 lds
buffer_load_dwordx4 v10, s[64:67], s7 offen offset:3072 sc1 lds
s_add_u32 m0, m0, 4096
s_add_u32 s7, s7, 4096
buffer_load_dwordx4 v10, s[64:67], s7 offen offset:0 sc1 lds
buffer_load_dwordx4 v10, s[64:67], s7 offen offset:1024 sc1 lds
buffer_load_dwordx4 v10, s[64:67], s7 offen offset:2048 sc1 lds
buffer_load_dwordx4 v10, s[64:67], s7 offen offset:3072 sc1 lds
s_add_u32 m0, m0, 4096
s_add_u32 s7, s7, 4096
buffer_load_dwordx4 v10, s[64:67], s7 offen offset:0 sc1 lds
s_mov_b32 s6, 0
K2_NOWFA:
s_lshl_b32 s25, s34, 2
s_add_u32 s36, s16, 1
s_and_b32 s36, s36, 3
s_add_u32 s48, s36, s25
s_lshl_b32 s52, s48, 8
s_add_u32 s52, s52, 14024704
s_mul_i32 s48, s48, 9216
s_add_u32 s48, s48, 4784128
s_mul_i32 s36, s36, 9216
s_add_u32 s37, s16, 2
s_and_b32 s37, s37, 3
s_add_u32 s49, s37, s25
s_lshl_b32 s53, s49, 8
s_add_u32 s53, s53, 14024704
s_mul_i32 s49, s49, 9216
s_add_u32 s49, s49, 4784128
s_mul_i32 s37, s37, 9216
s_add_u32 s38, s16, 3
s_and_b32 s38, s38, 3
s_add_u32 s50, s38, s25
s_lshl_b32 s54, s50, 8
s_add_u32 s54, s54, 14024704
s_mul_i32 s50, s50, 9216
s_add_u32 s50, s50, 4784128
s_mul_i32 s38, s38, 9216
v_and_b32 v82, 31, v1
v_lshlrev_b32 v88, 3, v82
s_lshl_b32 s25, s76, 10
v_add_u32 v5, s25, v10
s_lshl_b32 s21, s31, 12
s_lshl_b32 s26, s16, 10
s_add_u32 s21, s21, s26
s_add_u32 s21, s21, 21233664
v_min_u32 v11, 5, v1
v_lshlrev_b32 v11, 7, v11
v_add_u32 v11, s21, v11
v_add_u32 v89, 156672, v88
s_mul_i32 s26, s16, 9216
s_add_u32 s26, s26, 36864
v_bfe_u32 v82, v1, 4, 1
v_xor_b32 v82, 1, v82
s_mov_b32 s27, 73728
v_mad_u32_u24 v82, v82, s27, v5
v_add_u32 v90, s26, v82
s_add_u32 s26, s36, 36864
v_add_u32 v92, s26, v5
v_add_u32 v93, s26, v10
s_add_u32 s26, s36, 110592
s_add_u32 s19, s37, 110592
s_cmp_eq_u32 s76, 1
s_cselect_b32 s26, s19, s26
s_add_u32 s19, s38, 110592
s_cmp_eq_u32 s76, 2
s_cselect_b32 s26, s19, s26
s_add_u32 s19, s37, 36864
s_cmp_eq_u32 s76, 3
s_cselect_b32 s26, s19, s26
s_add_u32 s19, s38, 36864
s_cmp_eq_u32 s76, 4
s_cselect_b32 s26, s19, s26
v_and_b32 v82, 15, v1
v_lshrrev_b32 v83, 5, v1
v_lshl_add_u32 v82, v83, 4, v82
v_lshlrev_b32 v82, 4, v82
s_mul_i32 s27, s76, 9216
s_mov_b32 s28, 1024
s_cmp_eq_u32 s76, 4
s_cselect_b32 s28, 512, s28
s_cselect_b32 s27, 92160, s27
s_cselect_b64 vcc, -1, 0
v_cndmask_b32 v82, v10, v82, vcc
v_add_u32 v94, s27, v82
v_add_u32 v91, s26, v82
v_add_u32 v95, 147456, v10
s_cmp_eq_u32 s76, 2
s_cbranch_scc0 K2_NOPOLL
s_mov_b32 s23, 0
K2_POLL:
buffer_load_dword v9, v11, s[64:67], 0 offen sc1
s_add_u32 s23, s23, 1
s_waitcnt vmcnt(0)
v_cmp_ne_u32 vcc, s77, v9
s_cbranch_vccz K2_POLL_OK
s_sleep 1
s_cmp_lt_u32 s23, 400000
s_cbranch_scc1 K2_POLL
K2_POLL_OK:
K2_NOPOLL:
s_waitcnt vmcnt(0) lgkmcnt(0)
s_barrier
buffer_load_dwordx4 v[32:35], v5, s[64:67], s48 offen sc1
buffer_load_dwordx4 v[36:39], v5, s[64:67], s49 offen sc1
buffer_load_dwordx4 v[40:43], v5, s[64:67], s50 offen sc1
buffer_load_dwordx2 v[64:65], v88, s[64:67], s52 offen sc1
buffer_load_dwordx2 v[66:67], v88, s[64:67], s53 offen sc1
buffer_load_dwordx2 v[68:69], v88, s[64:67], s54 offen sc1
s_cmp_eq_u32 s76, 3
s_cbranch_scc0 K2_NOU8
v_add_u32 v9, 5120, v5
buffer_load_dwordx4 v[44:47], v9, s[64:67], s48 offen sc1
buffer_load_dwordx4 v[48:51], v9, s[64:67], s49 offen sc1
buffer_load_dwordx4 v[52:55], v9, s[64:67], s50 offen sc1
K2_NOU8:
ds_read_b64 v[70:71], v89
ds_read_b128 v[56:59], v90
ds_read_b128 v[60:63], v90 offset:5120
s_cmp_ge_u32 s76, 5
s_cbranch_scc1 K2_NOG1
ds_read_b128 a[108:111], v94
ds_read_b128 a[72:75], v95 offset:0
v_add_u32 v94, s28, v94
ds_read_b128 a[112:115], v94
ds_read_b128 a[76:79], v95 offset:1024
v_add_u32 v94, s28, v94
ds_read_b128 a[116:119], v94
ds_read_b128 a[80:83], v95 offset:2048
v_add_u32 v94, s28, v94
ds_read_b128 a[120:123], v94
ds_read_b128 a[84:87], v95 offset:3072
v_add_u32 v94, s28, v94
ds_read_b128 a[124:127], v94
ds_read_b128 a[88:91], v95 offset:4096
v_add_u32 v94, s28, v94
ds_read_b128 a[128:131], v94
ds_read_b128 a[92:95], v95 offset:5120
v_add_u32 v94, s28, v94
s_waitcnt lgkmcnt(10)
v_mfma_f32_32x32x16_bf16 v[16:31], a[108:111], a[72:75], 0
ds_read_b128 a[132:135], v94
ds_read_b128 a[96:99], v95 offset:6144
v_add_u32 v94, s28, v94
s_waitcnt lgkmcnt(10)
v_mfma_f32_32x32x16_bf16 v[16:31], a[112:115], a[76:79], v[16:31]
ds_read_b128 a[136:139], v94
ds_read_b128 a[100:103], v95 offset:7168
v_add_u32 v94, s28, v94
s_waitcnt lgkmcnt(10)
v_mfma_f32_32x32x16_bf16 v[16:31], a[116:119], a[80:83], v[16:31]
ds_read_b128 a[140:143], v94
ds_read_b128 a[104:107], v95 offset:8192
v_add_u32 v94, s28, v94
s_waitcnt lgkmcnt(10)
v_mfma_f32_32x32x16_bf16 v[16:31], a[120:123], a[84:87], v[16:31]
s_waitcnt lgkmcnt(8)
v_mfma_f32_32x32x16_bf16 v[16:31], a[124:127], a[88:91], v[16:31]
s_waitcnt lgkmcnt(6)
v_mfma_f32_32x32x16_bf16 v[16:31], a[128:131], a[92:95], v[16:31]
s_waitcnt lgkmcnt(4)
v_mfma_f32_32x32x16_bf16 v[16:31], a[132:135], a[96:99], v[16:31]
s_waitcnt lgkmcnt(2)
v_mfma_f32_32x32x16_bf16 v[16:31], a[136:139], a[100:103], v[16:31]
s_waitcnt lgkmcnt(0)
v_mfma_f32_32x32x16_bf16 v[16:31], a[140:143], a[104:107], v[16:31]
ds_read_b128 a[108:111], v91
v_add_u32 v91, s28, v91
ds_read_b128 a[112:115], v91
v_add_u32 v91, s28, v91
ds_read_b128 a[116:119], v91
v_add_u32 v91, s28, v91
ds_read_b128 a[120:123], v91
v_add_u32 v91, s28, v91
ds_read_b128 a[124:127], v91
v_add_u32 v91, s28, v91
ds_read_b128 a[128:131], v91
v_add_u32 v91, s28, v91
ds_read_b128 a[132:135], v91
v_add_u32 v91, s28, v91
ds_read_b128 a[136:139], v91
v_add_u32 v91, s28, v91
ds_read_b128 a[140:143], v91
v_add_u32 v91, s28, v91
K2_NOG1:
s_waitcnt vmcnt(0) lgkmcnt(0)
v_max_f32 v80, v64, v66
v_max3_f32 v80, v80, v68, v70
v_sub_f32 v64, v64, v80
v_sub_f32 v66, v66, v80
v_sub_f32 v68, v68, v80
v_sub_f32 v70, v70, v80
v_exp_f32 v64, v64
v_exp_f32 v66, v66
v_exp_f32 v68, v68
v_exp_f32 v70, v70
v_mul_f32 v64, v64, v65
v_mul_f32 v66, v66, v67
v_mul_f32 v68, v68, v69
v_mul_f32 v70, v70, v71
v_add_f32 v80, v64, v66
v_add_f32 v81, v68, v70
v_add_f32 v80, v80, v81
v_rcp_f32 v80, v80
s_nop 0
v_mul_f32 v64, v64, v80
v_mul_f32 v66, v66, v80
v_mul_f32 v68, v68, v80
v_mul_f32 v70, v70, v80
s_mov_b32 s23, s76
K2_COMB:
v_lshlrev_b32 v82, 16, v32
v_and_b32 v83, 0xffff0000, v32
v_pk_mul_f32 v[80:81], v[82:83], v[64:65] op_sel_hi:[1,0]
v_lshlrev_b32 v84, 16, v36
v_and_b32 v85, 0xffff0000, v36
v_pk_fma_f32 v[80:81], v[84:85], v[66:67], v[80:81] op_sel_hi:[1,0,1]
v_lshlrev_b32 v82, 16, v40
v_and_b32 v83, 0xffff0000, v40
v_pk_fma_f32 v[80:81], v[82:83], v[68:69], v[80:81] op_sel_hi:[1,0,1]
v_lshlrev_b32 v84, 16, v56
v_and_b32 v85, 0xffff0000, v56
v_pk_fma_f32 v[80:81], v[84:85], v[70:71], v[80:81] op_sel_hi:[1,0,1]
v_cvt_pk_bf16_f32 v72, v80, v81
v_lshlrev_b32 v82, 16, v33
v_and_b32 v83, 0xffff0000, v33
v_pk_mul_f32 v[80:81], v[82:83], v[64:65] op_sel_hi:[1,0]
v_lshlrev_b32 v84, 16, v37
v_and_b32 v85, 0xffff0000, v37
v_pk_fma_f32 v[80:81], v[84:85], v[66:67], v[80:81] op_sel_hi:[1,0,1]
v_lshlrev_b32 v82, 16, v41
v_and_b32 v83, 0xffff0000, v41
v_pk_fma_f32 v[80:81], v[82:83], v[68:69], v[80:81] op_sel_hi:[1,0,1]
v_lshlrev_b32 v84, 16, v57
v_and_b32 v85, 0xffff0000, v57
v_pk_fma_f32 v[80:81], v[84:85], v[70:71], v[80:81] op_sel_hi:[1,0,1]
v_cvt_pk_bf16_f32 v73, v80, v81
v_lshlrev_b32 v82, 16, v34
v_and_b32 v83, 0xffff0000, v34
v_pk_mul_f32 v[80:81], v[82:83], v[64:65] op_sel_hi:[1,0]
v_lshlrev_b32 v84, 16, v38
v_and_b32 v85, 0xffff0000, v38
v_pk_fma_f32 v[80:81], v[84:85], v[66:67], v[80:81] op_sel_hi:[1,0,1]
v_lshlrev_b32 v82, 16, v42
v_and_b32 v83, 0xffff0000, v42
v_pk_fma_f32 v[80:81], v[82:83], v[68:69], v[80:81] op_sel_hi:[1,0,1]
v_lshlrev_b32 v84, 16, v58
v_and_b32 v85, 0xffff0000, v58
v_pk_fma_f32 v[80:81], v[84:85], v[70:71], v[80:81] op_sel_hi:[1,0,1]
v_cvt_pk_bf16_f32 v74, v80, v81
v_lshlrev_b32 v82, 16, v35
v_and_b32 v83, 0xffff0000, v35
v_pk_mul_f32 v[80:81], v[82:83], v[64:65] op_sel_hi:[1,0]
v_lshlrev_b32 v84, 16, v39
v_and_b32 v85, 0xffff0000, v39
v_pk_fma_f32 v[80:81], v[84:85], v[66:67], v[80:81] op_sel_hi:[1,0,1]
v_lshlrev_b32 v82, 16, v43
v_and_b32 v83, 0xffff0000, v43
v_pk_fma_f32 v[80:81], v[82:83], v[68:69], v[80:81] op_sel_hi:[1,0,1]
v_lshlrev_b32 v84, 16, v59
v_and_b32 v85, 0xffff0000, v59
v_pk_fma_f32 v[80:81], v[84:85], v[70:71], v[80:81] op_sel_hi:[1,0,1]
v_cvt_pk_bf16_f32 v75, v80, v81
ds_write_b128 v92, v[72:75]
s_cmp_eq_u32 s23, 3
s_cbranch_scc0 K2_COMB_E
s_mov_b32 s23, 99
v_mov_b32 v32, v44
v_mov_b32 v33, v45
v_mov_b32 v34, v46
v_mov_b32 v35, v47
v_mov_b32 v36, v48
v_mov_b32 v37, v49
v_mov_b32 v38, v50
v_mov_b32 v39, v51
v_mov_b32 v40, v52
v_mov_b32 v41, v53
v_mov_b32 v42, v54
v_mov_b32 v43, v55
v_mov_b32 v56, v60
v_mov_b32 v57, v61
v_mov_b32 v58, v62
v_mov_b32 v59, v63
v_add_u32 v92, 5120, v92
s_branch K2_COMB
K2_COMB_E:
v_lshlrev_b32 v32, 16, v104
v_and_b32 v33, 0xffff0000, v104
v_lshlrev_b32 v34, 16, v105
v_and_b32 v35, 0xffff0000, v105
v_lshlrev_b32 v36, 16, v106
v_and_b32 v37, 0xffff0000, v106
v_lshlrev_b32 v38, 16, v107
v_and_b32 v39, 0xffff0000, v107
v_lshlrev_b32 v40, 16, v108
v_and_b32 v41, 0xffff0000, v108
v_lshlrev_b32 v42, 16, v109
v_and_b32 v43, 0xffff0000, v109
v_lshlrev_b32 v44, 16, v110
v_and_b32 v45, 0xffff0000, v110
v_lshlrev_b32 v46, 16, v111
v_and_b32 v47, 0xffff0000, v111
s_waitcnt vmcnt(0) lgkmcnt(0)
s_barrier
s_cmp_ge_u32 s76, 5
s_cbranch_scc1 K2_END2
ds_read_b128 a[72:75], v93 offset:0
ds_read_b128 a[76:79], v93 offset:1024
ds_read_b128 a[80:83], v93 offset:2048
ds_read_b128 a[84:87], v93 offset:3072
ds_read_b128 a[88:91], v93 offset:4096
ds_read_b128 a[92:95], v93 offset:5120
ds_read_b128 a[96:99], v93 offset:6144
ds_read_b128 a[100:103], v93 offset:7168
ds_read_b128 a[104:107], v93 offset:8192
s_waitcnt lgkmcnt(8)
v_mfma_f32_32x32x16_bf16 v[16:31], a[108:111], a[72:75], v[16:31]
s_waitcnt lgkmcnt(7)
v_mfma_f32_32x32x16_bf16 v[16:31], a[112:115], a[76:79], v[16:31]
s_waitcnt lgkmcnt(6)
v_mfma_f32_32x32x16_bf16 v[16:31], a[116:119], a[80:83], v[16:31]
s_waitcnt lgkmcnt(5)
v_mfma_f32_32x32x16_bf16 v[16:31], a[120:123], a[84:87], v[16:31]
s_waitcnt lgkmcnt(4)
v_mfma_f32_32x32x16_bf16 v[16:31], a[124:127], a[88:91], v[16:31]
s_waitcnt lgkmcnt(3)
v_mfma_f32_32x32x16_bf16 v[16:31], a[128:131], a[92:95], v[16:31]
s_waitcnt lgkmcnt(2)
v_mfma_f32_32x32x16_bf16 v[16:31], a[132:135], a[96:99], v[16:31]
s_waitcnt lgkmcnt(1)
v_mfma_f32_32x32x16_bf16 v[16:31], a[136:139], a[100:103], v[16:31]
s_waitcnt lgkmcnt(0)
v_mfma_f32_32x32x16_bf16 v[16:31], a[140:143], a[104:107], v[16:31]
s_nop 11
v_pk_add_f32 v[32:33], v[32:33], v[16:17]
v_pk_add_f32 v[34:35], v[34:35], v[18:19]
v_pk_add_f32 v[36:37], v[36:37], v[20:21]
v_pk_add_f32 v[38:39], v[38:39], v[22:23]
v_pk_add_f32 v[40:41], v[40:41], v[24:25]
v_pk_add_f32 v[42:43], v[42:43], v[26:27]
v_pk_add_f32 v[44:45], v[44:45], v[28:29]
v_pk_add_f32 v[46:47], v[46:47], v[30:31]
v_cvt_pk_bf16_f32 v104, v32, v33
v_cvt_pk_bf16_f32 v105, v34, v35
v_cvt_pk_bf16_f32 v106, v36, v37
v_cvt_pk_bf16_f32 v107, v38, v39
v_cvt_pk_bf16_f32 v108, v40, v41
v_cvt_pk_bf16_f32 v109, v42, v43
v_cvt_pk_bf16_f32 v110, v44, v45
v_cvt_pk_bf16_f32 v111, v46, v47
buffer_store_dwordx4 v[104:107], v4, s[72:75], s22 offen
s_cmp_eq_u32 s76, 4
s_cbranch_scc1 K2_END2
buffer_store_dwordx4 v[108:111], v4, s[72:75], s22 offen offset:32
K2_END2:
K2_END:
s_endpgm
K2_IDLE:
s_waitcnt vmcnt(5)
s_barrier
s_add_u32 m0, s24, s20
s_add_u32 s19, s18, 4096
buffer_load_dwordx4 v6, s[64:67], s18 offen offset:0 sc1 lds
buffer_load_dwordx4 v6, s[64:67], s18 offen offset:1024 sc1 lds
buffer_load_dwordx4 v6, s[64:67], s18 offen offset:2048 sc1 lds
buffer_load_dwordx4 v6, s[64:67], s18 offen offset:3072 sc1 lds
s_add_u32 m0, m0, 4096
s_mov_b64 exec, 0xffffffff
buffer_load_dwordx4 v6, s[64:67], s19 offen sc1 lds
s_mov_b64 exec, -1
s_add_u32 s18, s18, 18432
s_add_u32 s20, s20, 18432
s_cmp_ge_u32 s20, 73728
s_cselect_b32 s20, 0, s20
s_waitcnt vmcnt(5)
s_barrier
s_cmp_eq_u32 s8, 0
s_cbranch_scc1 K2_NDSb
s_mov_b32 exec_lo, s10
buffer_store_dwordx4 v[104:107], v98, s[64:67], s8 offen sc1
buffer_store_dwordx4 v[108:111], v98, s[64:67], s9 offen sc1
s_mov_b64 exec, -1
K2_NDSb:
s_nop 1
s_add_u32 m0, s24, s20
s_add_u32 s19, s18, 4096
buffer_load_dwordx4 v6, s[64:67], s18 offen offset:0 sc1 lds
buffer_load_dwordx4 v6, s[64:67], s18 offen offset:1024 sc1 lds
buffer_load_dwordx4 v6, s[64:67], s18 offen offset:2048 sc1 lds
buffer_load_dwordx4 v6, s[64:67], s18 offen offset:3072 sc1 lds
s_add_u32 m0, m0, 4096
s_mov_b64 exec, 0xffffffff
buffer_load_dwordx4 v6, s[64:67], s19 offen sc1 lds
s_mov_b64 exec, -1
s_add_u32 s18, s18, 18432
s_add_u32 s20, s20, 18432
s_cmp_ge_u32 s20, 73728
s_cselect_b32 s20, 0, s20
s_mov_b32 s23, 0
K2_IDLE_L:
s_waitcnt vmcnt(5)
s_barrier
s_cmp_eq_u32 s23, 4
s_cbranch_scc0 K2_IDLE_N
s_mov_b32 s23, 0
K2_C2I:
buffer_load_dword v97, v96, s[64:67], 0 offen sc1
s_add_u32 s23, s23, 1
s_waitcnt vmcnt(0)
v_cmp_ne_u32 vcc, s77, v97
s_cbranch_vccz K2_C2I_OK
s_sleep 1
s_cmp_lt_u32 s23, 400000
s_cbranch_scc1 K2_C2I
K2_C2I_OK:
s_mov_b32 s23, 4
K2_IDLE_N:
s_cmp_eq_u32 s2, 227
s_cbranch_scc0 K2_IDLE_E
s_cmp_eq_u32 s76, 1
s_cbranch_scc0 K2_IDLE_E
s_cmp_lt_u32 s23, 2
s_cbranch_scc1 K2_IDLE_E
s_cmp_eq_u32 s23, 6
s_cbranch_scc1 K2_IDLE_S
s_lshl_b32 s25, s23, 13
s_add_u32 s25, s25, 20971520
v_lshlrev_b32 v12, 7, v1
v_add_u32 v12, s25, v12
s_mov_b32 s26, s23
s_mov_b32 s23, 0
K2_EP:
buffer_load_dword v16, v12, s[64:67], 0 offen sc1
s_add_u32 s23, s23, 1
s_waitcnt vmcnt(0)
v_cmp_ne_u32 vcc, s77, v16
s_cbranch_vccz K2_EP_OK
s_sleep 1
s_cmp_lt_u32 s23, 400000
s_cbranch_scc1 K2_EP
K2_EP_OK:
s_mov_b32 s23, s26
s_branch K2_IDLE_E
K2_IDLE_S:
v_mov_b32 v12, 21020672
v_mov_b32 v13, s77
s_mov_b64 exec, 1
buffer_store_dword v13, v12, s[64:67], 0 offen sc1
s_mov_b64 exec, -1
K2_IDLE_E:
s_add_u32 m0, s24, s20
s_add_u32 s19, s18, 4096
buffer_load_dwordx4 v6, s[64:67], s18 offen offset:0 sc1 lds
buffer_load_dwordx4 v6, s[64:67], s18 offen offset:1024 sc1 lds
buffer_load_dwordx4 v6, s[64:67], s18 offen offset:2048 sc1 lds
buffer_load_dwordx4 v6, s[64:67], s18 offen offset:3072 sc1 lds
s_add_u32 m0, m0, 4096
s_mov_b64 exec, 0xffffffff
buffer_load_dwordx4 v6, s[64:67], s19 offen sc1 lds
s_mov_b64 exec, -1
s_add_u32 s18, s18, 18432
s_add_u32 s20, s20, 18432
s_cmp_ge_u32 s20, 73728
s_cselect_b32 s20, 0, s20
s_add_u32 s23, s23, 1
s_cmp_eq_u32 s23, 5
s_cselect_b32 s18, s32, s18
s_cmp_eq_u32 s23, 6
s_cselect_b32 s18, s33, s18
s_cmp_lt_u32 s23, 7
s_cbranch_scc1 K2_IDLE_L
s_mul_i32 s48, s34, 9216
s_lshl_b32 s49, s76, 10
s_add_u32 s50, s48, 14295040
s_add_u32 s49, s49, s48
s_add_u32 s49, s49, 14286848
buffer_load_dwordx4 v[96:99], v10, s[64:67], s49 offen sc1
buffer_load_dwordx4 v[100:103], v10, s[64:67], s50 offen sc1
v_and_b32 v4, 31, v1
v_mul_u32_u24 v4, 288, v4
v_lshrrev_b32 v5, 5, v1
v_lshl_add_u32 v4, v5, 4, v4
s_lshl_b32 s49, s76, 6
s_add_u32 s22, s48, s49
buffer_load_dwordx4 v[104:107], v4, s[68:71], s22 offen
buffer_load_dwordx4 v[108:111], v4, s[68:71], s22 offen offset:32
s_waitcnt vmcnt(0)
s_barrier
s_barrier
s_branch K2_E2W
K2_C2X:
s_cmp_eq_u32 s23, 0
s_cbranch_scc0 K2_C2W
s_cmp_eq_u32 s76, 0
s_cbranch_scc0 K2_C2R
v_lshrrev_b32 v98, 2, v10
v_mov_b32 v99, s77
s_mov_b64 exec, 0xffffffff
buffer_store_dword v99, v98, s[64:67], s78 offen sc1
s_mov_b64 exec, -1
s_branch K2_C2R
K2_C2W:
s_cmp_eq_u32 s23, 3
s_cbranch_scc0 K2_C2Y
buffer_load_dword v97, v96, s[64:67], 0 offen sc1
s_branch K2_C2R
K2_C2Y:
v_cmp_ne_u32 vcc, s77, v97
s_cbranch_vccz K2_C2R
s_mov_b32 s26, s23
s_mov_b32 s23, 0
K2_C2P:
buffer_load_dword v97, v96, s[64:67], 0 offen sc1
s_add_u32 s23, s23, 1
s_waitcnt vmcnt(0)
v_cmp_ne_u32 vcc, s77, v97
s_cbranch_vccz K2_C2P_OK
s_sleep 1
s_cmp_lt_u32 s23, 400000
s_cbranch_scc1 K2_C2P
K2_C2P_OK:
s_mov_b32 s23, s26
s_branch K2_C2R
K2_RARE_A:
s_nop 15
s_nop 15
s_nop 15
s_nop 15
v_max3_f32 v88, v32, v33, v34
v_max3_f32 v88, v88, v35, v36
v_max3_f32 v88, v88, v37, v38
v_max3_f32 v88, v88, v39, v40
v_max3_f32 v88, v88, v41, v42
v_max3_f32 v88, v88, v43, v44
v_max3_f32 v88, v88, v45, v46
v_max_f32 v88, v88, v47
v_mov_b32 v89, v88
s_nop 1
v_permlane32_swap_b32 v88, v89
v_max3_f32 v88, v88, v89, 0
v_sub_f32 v89, 0, v88
v_exp_f32 v89, v89
s_nop 0
v_mov_b32 v90, v89
v_mov_b32 v91, v89
s_nop 1
v_permlane16_swap_b32 v90, v91
v_accvgpr_read_b32 v80, a0
v_mul_f32 v80, v80, v90
v_accvgpr_write_b32 a0, v80
v_accvgpr_read_b32 v81, a1
v_mul_f32 v81, v81, v90
v_accvgpr_write_b32 a1, v81
v_accvgpr_read_b32 v82, a2
v_mul_f32 v82, v82, v90
v_accvgpr_write_b32 a2, v82
v_accvgpr_read_b32 v83, a3
v_mul_f32 v83, v83, v90
v_accvgpr_write_b32 a3, v83
v_accvgpr_read_b32 v84, a4
v_mul_f32 v84, v84, v90
v_accvgpr_write_b32 a4, v84
v_accvgpr_read_b32 v85, a5
v_mul_f32 v85, v85, v90
v_accvgpr_write_b32 a5, v85
v_accvgpr_read_b32 v86, a6
v_mul_f32 v86, v86, v90
v_accvgpr_write_b32 a6, v86
v_accvgpr_read_b32 v87, a7
v_mul_f32 v87, v87, v90
v_accvgpr_write_b32 a7, v87
v_accvgpr_read_b32 v80, a8
v_mul_f32 v80, v80, v90
v_accvgpr_write_b32 a8, v80
v_accvgpr_read_b32 v81, a9
v_mul_f32 v81, v81, v90
v_accvgpr_write_b32 a9, v81
v_accvgpr_read_b32 v82, a10
v_mul_f32 v82, v82, v90
v_accvgpr_write_b32 a10, v82
v_accvgpr_read_b32 v83, a11
v_mul_f32 v83, v83, v90
v_accvgpr_write_b32 a11, v83
v_accvgpr_read_b32 v84, a12
v_mul_f32 v84, v84, v90
v_accvgpr_write_b32 a12, v84
v_accvgpr_read_b32 v85, a13
v_mul_f32 v85, v85, v90
v_accvgpr_write_b32 a13, v85
v_accvgpr_read_b32 v86, a14
v_mul_f32 v86, v86, v90
v_accvgpr_write_b32 a14, v86
v_accvgpr_read_b32 v87, a15
v_mul_f32 v87, v87, v90
v_accvgpr_write_b32 a15, v87
v_accvgpr_read_b32 v80, a16
v_mul_f32 v80, v80, v90
v_accvgpr_write_b32 a16, v80
v_accvgpr_read_b32 v81, a17
v_mul_f32 v81, v81, v90
v_accvgpr_write_b32 a17, v81
v_accvgpr_read_b32 v82, a18
v_mul_f32 v82, v82, v90
v_accvgpr_write_b32 a18, v82
v_accvgpr_read_b32 v83, a19
v_mul_f32 v83, v83, v90
v_accvgpr_write_b32 a19, v83
v_accvgpr_read_b32 v84, a20
v_mul_f32 v84, v84, v90
v_accvgpr_write_b32 a20, v84
v_accvgpr_read_b32 v85, a21
v_mul_f32 v85, v85, v90
v_accvgpr_write_b32 a21, v85
v_accvgpr_read_b32 v86, a22
v_mul_f32 v86, v86, v90
v_accvgpr_write_b32 a22, v86
v_accvgpr_read_b32 v87, a23
v_mul_f32 v87, v87, v90
v_accvgpr_write_b32 a23, v87
v_accvgpr_read_b32 v80, a24
v_mul_f32 v80, v80, v90
v_accvgpr_write_b32 a24, v80
v_accvgpr_read_b32 v81, a25
v_mul_f32 v81, v81, v90
v_accvgpr_write_b32 a25, v81
v_accvgpr_read_b32 v82, a26
v_mul_f32 v82, v82, v90
v_accvgpr_write_b32 a26, v82
v_accvgpr_read_b32 v83, a27
v_mul_f32 v83, v83, v90
v_accvgpr_write_b32 a27, v83
v_accvgpr_read_b32 v84, a28
v_mul_f32 v84, v84, v90
v_accvgpr_write_b32 a28, v84
v_accvgpr_read_b32 v85, a29
v_mul_f32 v85, v85, v90
v_accvgpr_write_b32 a29, v85
v_accvgpr_read_b32 v86, a30
v_mul_f32 v86, v86, v90
v_accvgpr_write_b32 a30, v86
v_accvgpr_read_b32 v87, a31
v_mul_f32 v87, v87, v90
v_accvgpr_write_b32 a31, v87
v_accvgpr_read_b32 v80, a32
v_mul_f32 v80, v80, v90
v_accvgpr_write_b32 a32, v80
v_accvgpr_read_b32 v81, a33
v_mul_f32 v81, v81, v90
v_accvgpr_write_b32 a33, v81
v_accvgpr_read_b32 v82, a34
v_mul_f32 v82, v82, v90
v_accvgpr_write_b32 a34, v82
v_accvgpr_read_b32 v83, a35
v_mul_f32 v83, v83, v90
v_accvgpr_write_b32 a35, v83
v_accvgpr_read_b32 v84, a36
v_mul_f32 v84, v84, v91
v_accvgpr_write_b32 a36, v84
v_accvgpr_read_b32 v85, a37
v_mul_f32 v85, v85, v91
v_accvgpr_write_b32 a37, v85
v_accvgpr_read_b32 v86, a38
v_mul_f32 v86, v86, v91
v_accvgpr_write_b32 a38, v86
v_accvgpr_read_b32 v87, a39
v_mul_f32 v87, v87, v91
v_accvgpr_write_b32 a39, v87
v_accvgpr_read_b32 v80, a40
v_mul_f32 v80, v80, v91
v_accvgpr_write_b32 a40, v80
v_accvgpr_read_b32 v81, a41
v_mul_f32 v81, v81, v91
v_accvgpr_write_b32 a41, v81
v_accvgpr_read_b32 v82, a42
v_mul_f32 v82, v82, v91
v_accvgpr_write_b32 a42, v82
v_accvgpr_read_b32 v83, a43
v_mul_f32 v83, v83, v91
v_accvgpr_write_b32 a43, v83
v_accvgpr_read_b32 v84, a44
v_mul_f32 v84, v84, v91
v_accvgpr_write_b32 a44, v84
v_accvgpr_read_b32 v85, a45
v_mul_f32 v85, v85, v91
v_accvgpr_write_b32 a45, v85
v_accvgpr_read_b32 v86, a46
v_mul_f32 v86, v86, v91
v_accvgpr_write_b32 a46, v86
v_accvgpr_read_b32 v87, a47
v_mul_f32 v87, v87, v91
v_accvgpr_write_b32 a47, v87
v_accvgpr_read_b32 v80, a48
v_mul_f32 v80, v80, v91
v_accvgpr_write_b32 a48, v80
v_accvgpr_read_b32 v81, a49
v_mul_f32 v81, v81, v91
v_accvgpr_write_b32 a49, v81
v_accvgpr_read_b32 v82, a50
v_mul_f32 v82, v82, v91
v_accvgpr_write_b32 a50, v82
v_accvgpr_read_b32 v83, a51
v_mul_f32 v83, v83, v91
v_accvgpr_write_b32 a51, v83
v_accvgpr_read_b32 v84, a52
v_mul_f32 v84, v84, v91
v_accvgpr_write_b32 a52, v84
v_accvgpr_read_b32 v85, a53
v_mul_f32 v85, v85, v91
v_accvgpr_write_b32 a53, v85
v_accvgpr_read_b32 v86, a54
v_mul_f32 v86, v86, v91
v_accvgpr_write_b32 a54, v86
v_accvgpr_read_b32 v87, a55
v_mul_f32 v87, v87, v91
v_accvgpr_write_b32 a55, v87
v_accvgpr_read_b32 v80, a56
v_mul_f32 v80, v80, v91
v_accvgpr_write_b32 a56, v80
v_accvgpr_read_b32 v81, a57
v_mul_f32 v81, v81, v91
v_accvgpr_write_b32 a57, v81
v_accvgpr_read_b32 v82, a58
v_mul_f32 v82, v82, v91
v_accvgpr_write_b32 a58, v82
v_accvgpr_read_b32 v83, a59
v_mul_f32 v83, v83, v91
v_accvgpr_write_b32 a59, v83
v_accvgpr_read_b32 v84, a60
v_mul_f32 v84, v84, v91
v_accvgpr_write_b32 a60, v84
v_accvgpr_read_b32 v85, a61
v_mul_f32 v85, v85, v91
v_accvgpr_write_b32 a61, v85
v_accvgpr_read_b32 v86, a62
v_mul_f32 v86, v86, v91
v_accvgpr_write_b32 a62, v86
v_accvgpr_read_b32 v87, a63
v_mul_f32 v87, v87, v91
v_accvgpr_write_b32 a63, v87
v_accvgpr_read_b32 v80, a64
v_mul_f32 v80, v80, v91
v_accvgpr_write_b32 a64, v80
v_accvgpr_read_b32 v81, a65
v_mul_f32 v81, v81, v91
v_accvgpr_write_b32 a65, v81
v_accvgpr_read_b32 v82, a66
v_mul_f32 v82, v82, v91
v_accvgpr_write_b32 a66, v82
v_accvgpr_read_b32 v83, a67
v_mul_f32 v83, v83, v91
v_accvgpr_write_b32 a67, v83
v_accvgpr_read_b32 v84, a68
v_mul_f32 v84, v84, v91
v_accvgpr_write_b32 a68, v84
v_accvgpr_read_b32 v85, a69
v_mul_f32 v85, v85, v91
v_accvgpr_write_b32 a69, v85
v_accvgpr_read_b32 v86, a70
v_mul_f32 v86, v86, v91
v_accvgpr_write_b32 a70, v86
v_accvgpr_read_b32 v87, a71
v_mul_f32 v87, v87, v91
v_accvgpr_write_b32 a71, v87
v_mul_f32 v8, v8, v89
v_sub_f32 v48, v48, v88
v_sub_f32 v32, v32, v88
v_sub_f32 v16, v16, v88
v_sub_f32 v49, v49, v88
v_sub_f32 v33, v33, v88
v_sub_f32 v17, v17, v88
v_sub_f32 v50, v50, v88
v_sub_f32 v34, v34, v88
v_sub_f32 v18, v18, v88
v_sub_f32 v51, v51, v88
v_sub_f32 v35, v35, v88
v_sub_f32 v19, v19, v88
v_sub_f32 v52, v52, v88
v_sub_f32 v36, v36, v88
v_sub_f32 v20, v20, v88
v_sub_f32 v53, v53, v88
v_sub_f32 v37, v37, v88
v_sub_f32 v21, v21, v88
v_sub_f32 v54, v54, v88
v_sub_f32 v38, v38, v88
v_sub_f32 v22, v22, v88
v_sub_f32 v55, v55, v88
v_sub_f32 v39, v39, v88
v_sub_f32 v23, v23, v88
v_sub_f32 v56, v56, v88
v_sub_f32 v40, v40, v88
v_sub_f32 v24, v24, v88
v_sub_f32 v57, v57, v88
v_sub_f32 v41, v41, v88
v_sub_f32 v25, v25, v88
v_sub_f32 v58, v58, v88
v_sub_f32 v42, v42, v88
v_sub_f32 v26, v26, v88
v_sub_f32 v59, v59, v88
v_sub_f32 v43, v43, v88
v_sub_f32 v27, v27, v88
v_sub_f32 v60, v60, v88
v_sub_f32 v44, v44, v88
v_sub_f32 v28, v28, v88
v_sub_f32 v61, v61, v88
v_sub_f32 v45, v45, v88
v_sub_f32 v29, v29, v88
v_sub_f32 v62, v62, v88
v_sub_f32 v46, v46, v88
v_sub_f32 v30, v30, v88
v_sub_f32 v63, v63, v88
v_sub_f32 v47, v47, v88
v_sub_f32 v31, v31, v88
v_exp_f32 v80, v32
v_exp_f32 v81, v33
v_add_f32 v7, v8, v80
v_cvt_pk_bf16_f32 v72, v80, v81
v_add_f32 v7, v7, v81
v_exp_f32 v82, v40
v_exp_f32 v83, v41
v_add_f32 v7, v7, v82
v_cvt_pk_bf16_f32 v76, v82, v83
v_add_f32 v7, v7, v83
v_exp_f32 v84, v34
v_exp_f32 v85, v35
v_permlane16_swap_b32 v72, v76
v_add_f32 v7, v7, v84
v_cvt_pk_bf16_f32 v73, v84, v85
v_add_f32 v7, v7, v85
v_exp_f32 v86, v42
v_exp_f32 v87, v43
v_add_f32 v7, v7, v86
v_cvt_pk_bf16_f32 v77, v86, v87
v_add_f32 v7, v7, v87
v_exp_f32 v80, v36
v_exp_f32 v81, v37
v_permlane16_swap_b32 v73, v77
v_add_f32 v7, v7, v80
v_cvt_pk_bf16_f32 v74, v80, v81
v_add_f32 v7, v7, v81
v_exp_f32 v82, v44
v_exp_f32 v83, v45
v_add_f32 v7, v7, v82
v_cvt_pk_bf16_f32 v78, v82, v83
v_add_f32 v7, v7, v83
v_exp_f32 v84, v38
v_exp_f32 v85, v39
v_permlane16_swap_b32 v74, v78
v_add_f32 v7, v7, v84
v_cvt_pk_bf16_f32 v75, v84, v85
v_add_f32 v7, v7, v85
v_exp_f32 v86, v46
v_exp_f32 v87, v47
v_add_f32 v7, v7, v86
v_cvt_pk_bf16_f32 v79, v86, v87
v_add_f32 v7, v7, v87
s_nop 0
v_permlane16_swap_b32 v75, v79
s_nop 7
s_branch K2_RARE_A_ret
K2_RARE_B:
s_nop 15
s_nop 15
s_nop 15
s_nop 15
v_max3_f32 v88, v16, v17, v18
v_max3_f32 v88, v88, v19, v20
v_max3_f32 v88, v88, v21, v22
v_max3_f32 v88, v88, v23, v24
v_max3_f32 v88, v88, v25, v26
v_max3_f32 v88, v88, v27, v28
v_max3_f32 v88, v88, v29, v30
v_max_f32 v88, v88, v31
v_mov_b32 v89, v88
s_nop 1
v_permlane32_swap_b32 v88, v89
v_max3_f32 v88, v88, v89, 0
v_sub_f32 v89, 0, v88
v_exp_f32 v89, v89
s_nop 0
v_mov_b32 v90, v89
v_mov_b32 v91, v89
s_nop 1
v_permlane16_swap_b32 v90, v91
v_accvgpr_read_b32 v80, a0
v_mul_f32 v80, v80, v90
v_accvgpr_write_b32 a0, v80
v_accvgpr_read_b32 v81, a1
v_mul_f32 v81, v81, v90
v_accvgpr_write_b32 a1, v81
v_accvgpr_read_b32 v82, a2
v_mul_f32 v82, v82, v90
v_accvgpr_write_b32 a2, v82
v_accvgpr_read_b32 v83, a3
v_mul_f32 v83, v83, v90
v_accvgpr_write_b32 a3, v83
v_accvgpr_read_b32 v84, a4
v_mul_f32 v84, v84, v90
v_accvgpr_write_b32 a4, v84
v_accvgpr_read_b32 v85, a5
v_mul_f32 v85, v85, v90
v_accvgpr_write_b32 a5, v85
v_accvgpr_read_b32 v86, a6
v_mul_f32 v86, v86, v90
v_accvgpr_write_b32 a6, v86
v_accvgpr_read_b32 v87, a7
v_mul_f32 v87, v87, v90
v_accvgpr_write_b32 a7, v87
v_accvgpr_read_b32 v80, a8
v_mul_f32 v80, v80, v90
v_accvgpr_write_b32 a8, v80
v_accvgpr_read_b32 v81, a9
v_mul_f32 v81, v81, v90
v_accvgpr_write_b32 a9, v81
v_accvgpr_read_b32 v82, a10
v_mul_f32 v82, v82, v90
v_accvgpr_write_b32 a10, v82
v_accvgpr_read_b32 v83, a11
v_mul_f32 v83, v83, v90
v_accvgpr_write_b32 a11, v83
v_accvgpr_read_b32 v84, a12
v_mul_f32 v84, v84, v90
v_accvgpr_write_b32 a12, v84
v_accvgpr_read_b32 v85, a13
v_mul_f32 v85, v85, v90
v_accvgpr_write_b32 a13, v85
v_accvgpr_read_b32 v86, a14
v_mul_f32 v86, v86, v90
v_accvgpr_write_b32 a14, v86
v_accvgpr_read_b32 v87, a15
v_mul_f32 v87, v87, v90
v_accvgpr_write_b32 a15, v87
v_accvgpr_read_b32 v80, a16
v_mul_f32 v80, v80, v90
v_accvgpr_write_b32 a16, v80
v_accvgpr_read_b32 v81, a17
v_mul_f32 v81, v81, v90
v_accvgpr_write_b32 a17, v81
v_accvgpr_read_b32 v82, a18
v_mul_f32 v82, v82, v90
v_accvgpr_write_b32 a18, v82
v_accvgpr_read_b32 v83, a19
v_mul_f32 v83, v83, v90
v_accvgpr_write_b32 a19, v83
v_accvgpr_read_b32 v84, a20
v_mul_f32 v84, v84, v90
v_accvgpr_write_b32 a20, v84
v_accvgpr_read_b32 v85, a21
v_mul_f32 v85, v85, v90
v_accvgpr_write_b32 a21, v85
v_accvgpr_read_b32 v86, a22
v_mul_f32 v86, v86, v90
v_accvgpr_write_b32 a22, v86
v_accvgpr_read_b32 v87, a23
v_mul_f32 v87, v87, v90
v_accvgpr_write_b32 a23, v87
v_accvgpr_read_b32 v80, a24
v_mul_f32 v80, v80, v90
v_accvgpr_write_b32 a24, v80
v_accvgpr_read_b32 v81, a25
v_mul_f32 v81, v81, v90
v_accvgpr_write_b32 a25, v81
v_accvgpr_read_b32 v82, a26
v_mul_f32 v82, v82, v90
v_accvgpr_write_b32 a26, v82
v_accvgpr_read_b32 v83, a27
v_mul_f32 v83, v83, v90
v_accvgpr_write_b32 a27, v83
v_accvgpr_read_b32 v84, a28
v_mul_f32 v84, v84, v90
v_accvgpr_write_b32 a28, v84
v_accvgpr_read_b32 v85, a29
v_mul_f32 v85, v85, v90
v_accvgpr_write_b32 a29, v85
v_accvgpr_read_b32 v86, a30
v_mul_f32 v86, v86, v90
v_accvgpr_write_b32 a30, v86
v_accvgpr_read_b32 v87, a31
v_mul_f32 v87, v87, v90
v_accvgpr_write_b32 a31, v87
v_accvgpr_read_b32 v80, a32
v_mul_f32 v80, v80, v90
v_accvgpr_write_b32 a32, v80
v_accvgpr_read_b32 v81, a33
v_mul_f32 v81, v81, v90
v_accvgpr_write_b32 a33, v81
v_accvgpr_read_b32 v82, a34
v_mul_f32 v82, v82, v90
v_accvgpr_write_b32 a34, v82
v_accvgpr_read_b32 v83, a35
v_mul_f32 v83, v83, v90
v_accvgpr_write_b32 a35, v83
v_accvgpr_read_b32 v84, a36
v_mul_f32 v84, v84, v91
v_accvgpr_write_b32 a36, v84
v_accvgpr_read_b32 v85, a37
v_mul_f32 v85, v85, v91
v_accvgpr_write_b32 a37, v85
v_accvgpr_read_b32 v86, a38
v_mul_f32 v86, v86, v91
v_accvgpr_write_b32 a38, v86
v_accvgpr_read_b32 v87, a39
v_mul_f32 v87, v87, v91
v_accvgpr_write_b32 a39, v87
v_accvgpr_read_b32 v80, a40
v_mul_f32 v80, v80, v91
v_accvgpr_write_b32 a40, v80
v_accvgpr_read_b32 v81, a41
v_mul_f32 v81, v81, v91
v_accvgpr_write_b32 a41, v81
v_accvgpr_read_b32 v82, a42
v_mul_f32 v82, v82, v91
v_accvgpr_write_b32 a42, v82
v_accvgpr_read_b32 v83, a43
v_mul_f32 v83, v83, v91
v_accvgpr_write_b32 a43, v83
v_accvgpr_read_b32 v84, a44
v_mul_f32 v84, v84, v91
v_accvgpr_write_b32 a44, v84
v_accvgpr_read_b32 v85, a45
v_mul_f32 v85, v85, v91
v_accvgpr_write_b32 a45, v85
v_accvgpr_read_b32 v86, a46
v_mul_f32 v86, v86, v91
v_accvgpr_write_b32 a46, v86
v_accvgpr_read_b32 v87, a47
v_mul_f32 v87, v87, v91
v_accvgpr_write_b32 a47, v87
v_accvgpr_read_b32 v80, a48
v_mul_f32 v80, v80, v91
v_accvgpr_write_b32 a48, v80
v_accvgpr_read_b32 v81, a49
v_mul_f32 v81, v81, v91
v_accvgpr_write_b32 a49, v81
v_accvgpr_read_b32 v82, a50
v_mul_f32 v82, v82, v91
v_accvgpr_write_b32 a50, v82
v_accvgpr_read_b32 v83, a51
v_mul_f32 v83, v83, v91
v_accvgpr_write_b32 a51, v83
v_accvgpr_read_b32 v84, a52
v_mul_f32 v84, v84, v91
v_accvgpr_write_b32 a52, v84
v_accvgpr_read_b32 v85, a53
v_mul_f32 v85, v85, v91
v_accvgpr_write_b32 a53, v85
v_accvgpr_read_b32 v86, a54
v_mul_f32 v86, v86, v91
v_accvgpr_write_b32 a54, v86
v_accvgpr_read_b32 v87, a55
v_mul_f32 v87, v87, v91
v_accvgpr_write_b32 a55, v87
v_accvgpr_read_b32 v80, a56
v_mul_f32 v80, v80, v91
v_accvgpr_write_b32 a56, v80
v_accvgpr_read_b32 v81, a57
v_mul_f32 v81, v81, v91
v_accvgpr_write_b32 a57, v81
v_accvgpr_read_b32 v82, a58
v_mul_f32 v82, v82, v91
v_accvgpr_write_b32 a58, v82
v_accvgpr_read_b32 v83, a59
v_mul_f32 v83, v83, v91
v_accvgpr_write_b32 a59, v83
v_accvgpr_read_b32 v84, a60
v_mul_f32 v84, v84, v91
v_accvgpr_write_b32 a60, v84
v_accvgpr_read_b32 v85, a61
v_mul_f32 v85, v85, v91
v_accvgpr_write_b32 a61, v85
v_accvgpr_read_b32 v86, a62
v_mul_f32 v86, v86, v91
v_accvgpr_write_b32 a62, v86
v_accvgpr_read_b32 v87, a63
v_mul_f32 v87, v87, v91
v_accvgpr_write_b32 a63, v87
v_accvgpr_read_b32 v80, a64
v_mul_f32 v80, v80, v91
v_accvgpr_write_b32 a64, v80
v_accvgpr_read_b32 v81, a65
v_mul_f32 v81, v81, v91
v_accvgpr_write_b32 a65, v81
v_accvgpr_read_b32 v82, a66
v_mul_f32 v82, v82, v91
v_accvgpr_write_b32 a66, v82
v_accvgpr_read_b32 v83, a67
v_mul_f32 v83, v83, v91
v_accvgpr_write_b32 a67, v83
v_accvgpr_read_b32 v84, a68
v_mul_f32 v84, v84, v91
v_accvgpr_write_b32 a68, v84
v_accvgpr_read_b32 v85, a69
v_mul_f32 v85, v85, v91
v_accvgpr_write_b32 a69, v85
v_accvgpr_read_b32 v86, a70
v_mul_f32 v86, v86, v91
v_accvgpr_write_b32 a70, v86
v_accvgpr_read_b32 v87, a71
v_mul_f32 v87, v87, v91
v_accvgpr_write_b32 a71, v87
v_mul_f32 v7, v7, v89
v_sub_f32 v48, v48, v88
v_sub_f32 v16, v16, v88
v_sub_f32 v32, v32, v88
v_sub_f32 v49, v49, v88
v_sub_f32 v17, v17, v88
v_sub_f32 v33, v33, v88
v_sub_f32 v50, v50, v88
v_sub_f32 v18, v18, v88
v_sub_f32 v34, v34, v88
v_sub_f32 v51, v51, v88
v_sub_f32 v19, v19, v88
v_sub_f32 v35, v35, v88
v_sub_f32 v52, v52, v88
v_sub_f32 v20, v20, v88
v_sub_f32 v36, v36, v88
v_sub_f32 v53, v53, v88
v_sub_f32 v21, v21, v88
v_sub_f32 v37, v37, v88
v_sub_f32 v54, v54, v88
v_sub_f32 v22, v22, v88
v_sub_f32 v38, v38, v88
v_sub_f32 v55, v55, v88
v_sub_f32 v23, v23, v88
v_sub_f32 v39, v39, v88
v_sub_f32 v56, v56, v88
v_sub_f32 v24, v24, v88
v_sub_f32 v40, v40, v88
v_sub_f32 v57, v57, v88
v_sub_f32 v25, v25, v88
v_sub_f32 v41, v41, v88
v_sub_f32 v58, v58, v88
v_sub_f32 v26, v26, v88
v_sub_f32 v42, v42, v88
v_sub_f32 v59, v59, v88
v_sub_f32 v27, v27, v88
v_sub_f32 v43, v43, v88
v_sub_f32 v60, v60, v88
v_sub_f32 v28, v28, v88
v_sub_f32 v44, v44, v88
v_sub_f32 v61, v61, v88
v_sub_f32 v29, v29, v88
v_sub_f32 v45, v45, v88
v_sub_f32 v62, v62, v88
v_sub_f32 v30, v30, v88
v_sub_f32 v46, v46, v88
v_sub_f32 v63, v63, v88
v_sub_f32 v31, v31, v88
v_sub_f32 v47, v47, v88
v_exp_f32 v80, v16
v_exp_f32 v81, v17
v_add_f32 v8, v7, v80
v_cvt_pk_bf16_f32 v64, v80, v81
v_add_f32 v8, v8, v81
v_exp_f32 v82, v24
v_exp_f32 v83, v25
v_add_f32 v8, v8, v82
v_cvt_pk_bf16_f32 v68, v82, v83
v_add_f32 v8, v8, v83
v_exp_f32 v84, v18
v_exp_f32 v85, v19
v_permlane16_swap_b32 v64, v68
v_add_f32 v8, v8, v84
v_cvt_pk_bf16_f32 v65, v84, v85
v_add_f32 v8, v8, v85
v_exp_f32 v86, v26
v_exp_f32 v87, v27
v_add_f32 v8, v8, v86
v_cvt_pk_bf16_f32 v69, v86, v87
v_add_f32 v8, v8, v87
v_exp_f32 v80, v20
v_exp_f32 v81, v21
v_permlane16_swap_b32 v65, v69
v_add_f32 v8, v8, v80
v_cvt_pk_bf16_f32 v66, v80, v81
v_add_f32 v8, v8, v81
v_exp_f32 v82, v28
v_exp_f32 v83, v29
v_add_f32 v8, v8, v82
v_cvt_pk_bf16_f32 v70, v82, v83
v_add_f32 v8, v8, v83
v_exp_f32 v84, v22
v_exp_f32 v85, v23
v_permlane16_swap_b32 v66, v70
v_add_f32 v8, v8, v84
v_cvt_pk_bf16_f32 v67, v84, v85
v_add_f32 v8, v8, v85
v_exp_f32 v86, v30
v_exp_f32 v87, v31
v_add_f32 v8, v8, v86
v_cvt_pk_bf16_f32 v71, v86, v87
v_add_f32 v8, v8, v87
s_nop 0
v_permlane16_swap_b32 v67, v71
s_nop 7
s_branch K2_RARE_B_ret
K2_RARE_T:
s_nop 15
s_nop 15
s_nop 15
s_nop 15
v_max3_f32 v88, v32, v33, v34
v_max3_f32 v88, v88, v35, v36
v_max3_f32 v88, v88, v37, v38
v_max3_f32 v88, v88, v39, v40
v_max3_f32 v88, v88, v41, v42
v_max3_f32 v88, v88, v43, v44
v_max3_f32 v88, v88, v45, v46
v_max_f32 v88, v88, v47
v_mov_b32 v89, v88
s_nop 1
v_permlane32_swap_b32 v88, v89
v_max3_f32 v88, v88, v89, 0
v_sub_f32 v89, 0, v88
v_exp_f32 v89, v89
s_nop 0
v_mov_b32 v90, v89
v_mov_b32 v91, v89
s_nop 1
v_permlane16_swap_b32 v90, v91
v_accvgpr_read_b32 v80, a0
v_mul_f32 v80, v80, v90
v_accvgpr_write_b32 a0, v80
v_accvgpr_read_b32 v81, a1
v_mul_f32 v81, v81, v90
v_accvgpr_write_b32 a1, v81
v_accvgpr_read_b32 v82, a2
v_mul_f32 v82, v82, v90
v_accvgpr_write_b32 a2, v82
v_accvgpr_read_b32 v83, a3
v_mul_f32 v83, v83, v90
v_accvgpr_write_b32 a3, v83
v_accvgpr_read_b32 v84, a4
v_mul_f32 v84, v84, v90
v_accvgpr_write_b32 a4, v84
v_accvgpr_read_b32 v85, a5
v_mul_f32 v85, v85, v90
v_accvgpr_write_b32 a5, v85
v_accvgpr_read_b32 v86, a6
v_mul_f32 v86, v86, v90
v_accvgpr_write_b32 a6, v86
v_accvgpr_read_b32 v87, a7
v_mul_f32 v87, v87, v90
v_accvgpr_write_b32 a7, v87
v_accvgpr_read_b32 v80, a8
v_mul_f32 v80, v80, v90
v_accvgpr_write_b32 a8, v80
v_accvgpr_read_b32 v81, a9
v_mul_f32 v81, v81, v90
v_accvgpr_write_b32 a9, v81
v_accvgpr_read_b32 v82, a10
v_mul_f32 v82, v82, v90
v_accvgpr_write_b32 a10, v82
v_accvgpr_read_b32 v83, a11
v_mul_f32 v83, v83, v90
v_accvgpr_write_b32 a11, v83
v_accvgpr_read_b32 v84, a12
v_mul_f32 v84, v84, v90
v_accvgpr_write_b32 a12, v84
v_accvgpr_read_b32 v85, a13
v_mul_f32 v85, v85, v90
v_accvgpr_write_b32 a13, v85
v_accvgpr_read_b32 v86, a14
v_mul_f32 v86, v86, v90
v_accvgpr_write_b32 a14, v86
v_accvgpr_read_b32 v87, a15
v_mul_f32 v87, v87, v90
v_accvgpr_write_b32 a15, v87
v_accvgpr_read_b32 v80, a16
v_mul_f32 v80, v80, v90
v_accvgpr_write_b32 a16, v80
v_accvgpr_read_b32 v81, a17
v_mul_f32 v81, v81, v90
v_accvgpr_write_b32 a17, v81
v_accvgpr_read_b32 v82, a18
v_mul_f32 v82, v82, v90
v_accvgpr_write_b32 a18, v82
v_accvgpr_read_b32 v83, a19
v_mul_f32 v83, v83, v90
v_accvgpr_write_b32 a19, v83
v_accvgpr_read_b32 v84, a20
v_mul_f32 v84, v84, v90
v_accvgpr_write_b32 a20, v84
v_accvgpr_read_b32 v85, a21
v_mul_f32 v85, v85, v90
v_accvgpr_write_b32 a21, v85
v_accvgpr_read_b32 v86, a22
v_mul_f32 v86, v86, v90
v_accvgpr_write_b32 a22, v86
v_accvgpr_read_b32 v87, a23
v_mul_f32 v87, v87, v90
v_accvgpr_write_b32 a23, v87
v_accvgpr_read_b32 v80, a24
v_mul_f32 v80, v80, v90
v_accvgpr_write_b32 a24, v80
v_accvgpr_read_b32 v81, a25
v_mul_f32 v81, v81, v90
v_accvgpr_write_b32 a25, v81
v_accvgpr_read_b32 v82, a26
v_mul_f32 v82, v82, v90
v_accvgpr_write_b32 a26, v82
v_accvgpr_read_b32 v83, a27
v_mul_f32 v83, v83, v90
v_accvgpr_write_b32 a27, v83
v_accvgpr_read_b32 v84, a28
v_mul_f32 v84, v84, v90
v_accvgpr_write_b32 a28, v84
v_accvgpr_read_b32 v85, a29
v_mul_f32 v85, v85, v90
v_accvgpr_write_b32 a29, v85
v_accvgpr_read_b32 v86, a30
v_mul_f32 v86, v86, v90
v_accvgpr_write_b32 a30, v86
v_accvgpr_read_b32 v87, a31
v_mul_f32 v87, v87, v90
v_accvgpr_write_b32 a31, v87
v_accvgpr_read_b32 v80, a32
v_mul_f32 v80, v80, v90
v_accvgpr_write_b32 a32, v80
v_accvgpr_read_b32 v81, a33
v_mul_f32 v81, v81, v90
v_accvgpr_write_b32 a33, v81
v_accvgpr_read_b32 v82, a34
v_mul_f32 v82, v82, v90
v_accvgpr_write_b32 a34, v82
v_accvgpr_read_b32 v83, a35
v_mul_f32 v83, v83, v90
v_accvgpr_write_b32 a35, v83
v_accvgpr_read_b32 v84, a36
v_mul_f32 v84, v84, v91
v_accvgpr_write_b32 a36, v84
v_accvgpr_read_b32 v85, a37
v_mul_f32 v85, v85, v91
v_accvgpr_write_b32 a37, v85
v_accvgpr_read_b32 v86, a38
v_mul_f32 v86, v86, v91
v_accvgpr_write_b32 a38, v86
v_accvgpr_read_b32 v87, a39
v_mul_f32 v87, v87, v91
v_accvgpr_write_b32 a39, v87
v_accvgpr_read_b32 v80, a40
v_mul_f32 v80, v80, v91
v_accvgpr_write_b32 a40, v80
v_accvgpr_read_b32 v81, a41
v_mul_f32 v81, v81, v91
v_accvgpr_write_b32 a41, v81
v_accvgpr_read_b32 v82, a42
v_mul_f32 v82, v82, v91
v_accvgpr_write_b32 a42, v82
v_accvgpr_read_b32 v83, a43
v_mul_f32 v83, v83, v91
v_accvgpr_write_b32 a43, v83
v_accvgpr_read_b32 v84, a44
v_mul_f32 v84, v84, v91
v_accvgpr_write_b32 a44, v84
v_accvgpr_read_b32 v85, a45
v_mul_f32 v85, v85, v91
v_accvgpr_write_b32 a45, v85
v_accvgpr_read_b32 v86, a46
v_mul_f32 v86, v86, v91
v_accvgpr_write_b32 a46, v86
v_accvgpr_read_b32 v87, a47
v_mul_f32 v87, v87, v91
v_accvgpr_write_b32 a47, v87
v_accvgpr_read_b32 v80, a48
v_mul_f32 v80, v80, v91
v_accvgpr_write_b32 a48, v80
v_accvgpr_read_b32 v81, a49
v_mul_f32 v81, v81, v91
v_accvgpr_write_b32 a49, v81
v_accvgpr_read_b32 v82, a50
v_mul_f32 v82, v82, v91
v_accvgpr_write_b32 a50, v82
v_accvgpr_read_b32 v83, a51
v_mul_f32 v83, v83, v91
v_accvgpr_write_b32 a51, v83
v_accvgpr_read_b32 v84, a52
v_mul_f32 v84, v84, v91
v_accvgpr_write_b32 a52, v84
v_accvgpr_read_b32 v85, a53
v_mul_f32 v85, v85, v91
v_accvgpr_write_b32 a53, v85
v_accvgpr_read_b32 v86, a54
v_mul_f32 v86, v86, v91
v_accvgpr_write_b32 a54, v86
v_accvgpr_read_b32 v87, a55
v_mul_f32 v87, v87, v91
v_accvgpr_write_b32 a55, v87
v_accvgpr_read_b32 v80, a56
v_mul_f32 v80, v80, v91
v_accvgpr_write_b32 a56, v80
v_accvgpr_read_b32 v81, a57
v_mul_f32 v81, v81, v91
v_accvgpr_write_b32 a57, v81
v_accvgpr_read_b32 v82, a58
v_mul_f32 v82, v82, v91
v_accvgpr_write_b32 a58, v82
v_accvgpr_read_b32 v83, a59
v_mul_f32 v83, v83, v91
v_accvgpr_write_b32 a59, v83
v_accvgpr_read_b32 v84, a60
v_mul_f32 v84, v84, v91
v_accvgpr_write_b32 a60, v84
v_accvgpr_read_b32 v85, a61
v_mul_f32 v85, v85, v91
v_accvgpr_write_b32 a61, v85
v_accvgpr_read_b32 v86, a62
v_mul_f32 v86, v86, v91
v_accvgpr_write_b32 a62, v86
v_accvgpr_read_b32 v87, a63
v_mul_f32 v87, v87, v91
v_accvgpr_write_b32 a63, v87
v_accvgpr_read_b32 v80, a64
v_mul_f32 v80, v80, v91
v_accvgpr_write_b32 a64, v80
v_accvgpr_read_b32 v81, a65
v_mul_f32 v81, v81, v91
v_accvgpr_write_b32 a65, v81
v_accvgpr_read_b32 v82, a66
v_mul_f32 v82, v82, v91
v_accvgpr_write_b32 a66, v82
v_accvgpr_read_b32 v83, a67
v_mul_f32 v83, v83, v91
v_accvgpr_write_b32 a67, v83
v_accvgpr_read_b32 v84, a68
v_mul_f32 v84, v84, v91
v_accvgpr_write_b32 a68, v84
v_accvgpr_read_b32 v85, a69
v_mul_f32 v85, v85, v91
v_accvgpr_write_b32 a69, v85
v_accvgpr_read_b32 v86, a70
v_mul_f32 v86, v86, v91
v_accvgpr_write_b32 a70, v86
v_accvgpr_read_b32 v87, a71
v_mul_f32 v87, v87, v91
v_accvgpr_write_b32 a71, v87
v_mul_f32 v8, v8, v89
v_sub_f32 v48, v48, v88
v_sub_f32 v32, v32, v88
v_sub_f32 v16, v16, v88
v_sub_f32 v49, v49, v88
v_sub_f32 v33, v33, v88
v_sub_f32 v17, v17, v88
v_sub_f32 v50, v50, v88
v_sub_f32 v34, v34, v88
v_sub_f32 v18, v18, v88
v_sub_f32 v51, v51, v88
v_sub_f32 v35, v35, v88
v_sub_f32 v19, v19, v88
v_sub_f32 v52, v52, v88
v_sub_f32 v36, v36, v88
v_sub_f32 v20, v20, v88
v_sub_f32 v53, v53, v88
v_sub_f32 v37, v37, v88
v_sub_f32 v21, v21, v88
v_sub_f32 v54, v54, v88
v_sub_f32 v38, v38, v88
v_sub_f32 v22, v22, v88
v_sub_f32 v55, v55, v88
v_sub_f32 v39, v39, v88
v_sub_f32 v23, v23, v88
v_sub_f32 v56, v56, v88
v_sub_f32 v40, v40, v88
v_sub_f32 v24, v24, v88
v_sub_f32 v57, v57, v88
v_sub_f32 v41, v41, v88
v_sub_f32 v25, v25, v88
v_sub_f32 v58, v58, v88
v_sub_f32 v42, v42, v88
v_sub_f32 v26, v26, v88
v_sub_f32 v59, v59, v88
v_sub_f32 v43, v43, v88
v_sub_f32 v27, v27, v88
v_sub_f32 v60, v60, v88
v_sub_f32 v44, v44, v88
v_sub_f32 v28, v28, v88
v_sub_f32 v61, v61, v88
v_sub_f32 v45, v45, v88
v_sub_f32 v29, v29, v88
v_sub_f32 v62, v62, v88
v_sub_f32 v46, v46, v88
v_sub_f32 v30, v30, v88
v_sub_f32 v63, v63, v88
v_sub_f32 v47, v47, v88
v_sub_f32 v31, v31, v88
v_exp_f32 v80, v32
v_exp_f32 v81, v33
v_add_f32 v7, v8, v80
v_cvt_pk_bf16_f32 v72, v80, v81
v_add_f32 v7, v7, v81
v_exp_f32 v82, v40
v_exp_f32 v83, v41
v_add_f32 v7, v7, v82
v_cvt_pk_bf16_f32 v76, v82, v83
v_add_f32 v7, v7, v83
v_exp_f32 v84, v34
v_exp_f32 v85, v35
v_permlane16_swap_b32 v72, v76
v_add_f32 v7, v7, v84
v_cvt_pk_bf16_f32 v73, v84, v85
v_add_f32 v7, v7, v85
v_exp_f32 v86, v42
v_exp_f32 v87, v43
v_add_f32 v7, v7, v86
v_cvt_pk_bf16_f32 v77, v86, v87
v_add_f32 v7, v7, v87
v_exp_f32 v80, v36
v_exp_f32 v81, v37
v_permlane16_swap_b32 v73, v77
v_add_f32 v7, v7, v80
v_cvt_pk_bf16_f32 v74, v80, v81
v_add_f32 v7, v7, v81
v_exp_f32 v82, v44
v_exp_f32 v83, v45
v_add_f32 v7, v7, v82
v_cvt_pk_bf16_f32 v78, v82, v83
v_add_f32 v7, v7, v83
v_exp_f32 v84, v38
v_exp_f32 v85, v39
v_permlane16_swap_b32 v74, v78
v_add_f32 v7, v7, v84
v_cvt_pk_bf16_f32 v75, v84, v85
v_add_f32 v7, v7, v85
v_exp_f32 v86, v46
v_exp_f32 v87, v47
v_add_f32 v7, v7, v86
v_cvt_pk_bf16_f32 v79, v86, v87
v_add_f32 v7, v7, v87
s_nop 0
v_permlane16_swap_b32 v75, v79
s_nop 7
s_branch K2_RARE_T_ret
.section .rodata,"a"
.p2align 6
.amdhsa_kernel standalone__conformer_family_branchformer__speech_kernel
  .amdhsa_next_free_vgpr 256
  .amdhsa_next_free_sgpr 96
  .amdhsa_accum_offset 112
  .amdhsa_group_segment_fixed_size 0
  .amdhsa_kernarg_size 96
  .amdhsa_user_sgpr_count 2
  .amdhsa_user_sgpr_kernarg_segment_ptr 1
  .amdhsa_system_sgpr_workgroup_id_x 1
.end_amdhsa_kernel
```
